```python
import torch

def _softmax(x, axis=-1):
    return torch.softmax(x, dim=axis)
def _gelu(x):
    return torch.nn.functional.gelu(x, approximate="tanh")
def _silu(x):
    return torch.nn.functional.silu(x)
def _sigmoid(x):
    return torch.sigmoid(x)
def _layernorm(x, axis=-1, eps=1e-5):
    m = x.mean(dim=axis, keepdim=True)
    v = x.var(dim=axis, keepdim=True, unbiased=False)
    return (x - m) / torch.sqrt(v + eps)
def _scatter_add(tgt, idx, src, axis=0):
    return tgt.clone().index_add_(axis, idx, src)
def _segment_sum(src, seg, n):
    out = torch.zeros((n,) + src.shape[1:], dtype=src.dtype)
    return out.index_add_(0, seg, src)
def _pad(x, pw):
    flat = tuple(v for pair in reversed(pw) for v in pair)
    return torch.nn.functional.pad(x, flat)

kernel_name = 'gated_mix__linear_kernel_hedgehog__ssm_conv_s4__prompt'

def setup_inputs():

    _w = (lambda a: (lambda t: t.to(torch.bfloat16) if t.is_floating_point() else t)(torch.as_tensor(a)))
    def _A_setup():
        B, S, D, H = 1, 2048, 448, 16
        Dh = D // H
        return {
            "x": _w((lambda *s: torch.randn(*s, dtype=torch.bfloat16) * 0.05)(B, S, D)),
            "wqkv": _w((lambda *s: torch.randn(*s, dtype=torch.bfloat16) * 0.8)(D, 3 * D)),
            "w_phi": _w((lambda *s: torch.randn(*s, dtype=torch.bfloat16) * 0.8)(H, Dh, Dh) * (Dh ** -0.5)),
            "wo": _w((lambda *s: torch.randn(*s, dtype=torch.bfloat16) * 0.05)(D, D)),
        }
    _A_in = _A_setup()

    def _B_setup():
        B, L, D, N = 1, 2048, 448, 256
        A_re = -(lambda _x: torch.exp(torch.as_tensor(_x)))((lambda *s: torch.randn(*s, dtype=torch.bfloat16) * 6.4)(D, N))
        A_im = torch.pi * (lambda *s: torch.randn(*s, dtype=torch.bfloat16) * 0.05)(D, N)
        B_re = (lambda *s: torch.randn(*s, dtype=torch.bfloat16) * 0.1)(D, N)
        B_im = (lambda *s: torch.randn(*s, dtype=torch.bfloat16) * 0.1)(D, N)
        C_re = (lambda *s: torch.randn(*s, dtype=torch.bfloat16) * 0.1)(D, N)
        C_im = (lambda *s: torch.randn(*s, dtype=torch.bfloat16) * 0.1)(D, N)
        log_dt = (lambda *s: torch.randn(*s, dtype=torch.bfloat16) * 0.05)(D) * 0.5 - 4.0
        Dskip = (lambda *s: torch.randn(*s, dtype=torch.bfloat16) * 0.05)(D)
        return {
            "u": _w((lambda *s: torch.randn(*s, dtype=torch.bfloat16) * 0.05)(B, L, D)),
            "A_re": _w(A_re),
            "A_im": _w(A_im),
            "B_re": _w(B_re),
            "B_im": _w(B_im),
            "C_re": _w(C_re),
            "C_im": _w(C_im),
            "log_dt": _w(log_dt),
            "Dskip": _w(Dskip),
        }
    _B_in = _B_setup()

    return {
        "A_x": _A_in["x"],
        "A_wqkv": _A_in["wqkv"],
        "A_w_phi": _A_in["w_phi"],
        "A_wo": _A_in["wo"],
        "B_u": _B_in["u"],
        "B_A_re": _B_in["A_re"],
        "B_A_im": _B_in["A_im"],
        "B_B_re": _B_in["B_re"],
        "B_B_im": _B_in["B_im"],
        "B_C_re": _B_in["C_re"],
        "B_C_im": _B_in["C_im"],
        "B_log_dt": _B_in["log_dt"],
        "B_Dskip": _B_in["Dskip"],
        "gate_w": _w((lambda *s: torch.randn(*s, dtype=torch.bfloat16) * 0.05)(448) * 16.0),
    }

def reference(A_x, A_wqkv, A_w_phi, A_wo, B_u, B_A_re, B_A_im, B_B_re, B_B_im, B_C_re, B_C_im, B_log_dt, B_Dskip, gate_w):
    def _A_ref(x, wqkv, w_phi, wo):
        B, S, D = x.shape
        H = 16; Dh = D // H
        qkv = (lambda x, *d: x.permute(*d))((x @ wqkv).reshape(B, S, 3, H, Dh), 2, 0, 3, 1, 4)
        q, k, v = qkv[0], qkv[1], qkv[2]
        pq = torch.einsum("bhsd,hdf->bhsf", q, w_phi)
        pk = torch.einsum("bhsd,hdf->bhsf", k, w_phi)
        phi_q = torch.concatenate([_softmax(pq, axis=-1), _softmax(-pq, axis=-1)], axis=-1)
        phi_k = torch.concatenate([_softmax(pk, axis=-1), _softmax(-pk, axis=-1)], axis=-1)
        kv = torch.einsum("bhsf,bhsd->bhfd", phi_k, v)
        z  = torch.einsum("bhsf->bhf", phi_k)
        num = torch.einsum("bhqf,bhfd->bhqd", phi_q, kv)
        den = torch.einsum("bhqf,bhf->bhq", phi_q, z)[..., None] + 1e-6
        o = num / den
        return (lambda x, *d: x.permute(*d))(o, 0, 2, 1, 3).reshape(B, S, D) @ wo

    def _B_ref(u, A_re, A_im, B_re, B_im, C_re, C_im, log_dt, Dskip):
        Bsz, L, D = u.shape
        dt = torch.exp(log_dt)[:, None]
        A = A_re + 1j * A_im
        Bc = B_re + 1j * B_im
        Cc = C_re + 1j * C_im
        logdA = dt * A
        dB = dt * Bc
        l = (lambda x, dt: x.to(dt))(torch.arange(L), A_re.dtype)
        P = torch.exp(logdA[:, :, None] * l[None, None, :])
        K = torch.einsum("dn,dnl,dn->dl", Cc, P, dB).real
        L2 = 2 * L
        Kp = _pad(K, ((0, 0), (0, L)))
        up = (lambda x, *d: x.permute(*d))(u, 0, 2, 1)
        up = _pad(up, ((0, 0), (0, 0), (0, L)))
        Kf = (lambda x, axes=(-2,-1): torch.fft.rfft2(x.float(), dim=axes))(Kp[:, None, :], axes=(-2, -1))
        Uf = (lambda x, axes=(-2,-1): torch.fft.rfft2(x.float(), dim=axes))(up[:, :, None, :], axes=(-2, -1))
        Yf = Uf * Kf[None, :, :, :]
        y = (lambda x, s, axes=(-2,-1): torch.fft.irfft2(x, s=s, dim=axes).to(torch.bfloat16))(Yf, (1, L2), axes=(-2, -1))[:, :, 0, :L]
        y = (lambda x, *d: x.permute(*d))(y, 0, 2, 1) + u * Dskip[None, None, :]
        return y

    x = A_x
    g = _sigmoid((x * gate_w).sum(-1, keepdims=True))
    a = _A_ref(x, A_wqkv, A_w_phi, A_wo)
    b = _B_ref(x, B_A_re, B_A_im, B_B_re, B_B_im, B_C_re, B_C_im, B_log_dt, B_Dskip)
    return g * a + (1 - g) * b
```

```asm
; @launch grid=(240,1,1) block=(512,1,1) lds=163840
.amdgcn_target "amdgcn-amd-amdhsa--gfx950"
.text
.globl gated_mix__linear_kernel_hedgehog__ssm_conv_s4__prompt_kernel
.p2align 8
.type gated_mix__linear_kernel_hedgehog__ssm_conv_s4__prompt_kernel,@function
gated_mix__linear_kernel_hedgehog__ssm_conv_s4__prompt_kernel:
  s_cmp_ge_u32 s2, 240
  s_cbranch_scc1 LK1_exit
  s_load_dwordx2 s[80:81], s[0:1], 24
  s_and_b32 s84, s2, 7
  s_lshr_b32 s85, s2, 3
  s_lshl_b32 s84, s84, 2
  s_and_b32 s86, s85, 3
  s_add_u32 s86, s84, s86
  s_lshr_b32 s84, s85, 2
  s_mov_b32 s85, s86
  s_mov_b32 s82, 401408
  s_mov_b32 s83, 0x00020000
  s_cmp_ge_u32 s2, 128
  s_cbranch_scc1 LK1_B
  s_load_dwordx4 s[36:39], s[0:1], 0
  s_load_dwordx2 s[40:41], s[0:1], 16
  s_load_dwordx2 s[24:25], s[0:1], 104
  s_load_dwordx4 s[32:35], s[0:1], 120
  v_and_b32 v1, 63, v0
  v_lshrrev_b32 v2, 6, v0
  s_and_b32 s3, s2, 7
  s_lshr_b32 s4, s2, 3
  v_readfirstlane_b32 s6, v2
  s_lshr_b32 s5, s3, 1
  s_lshl_b32 s5, s5, 1
  s_and_b32 s42, s4, 1
  s_add_u32 s5, s5, s42
  s_and_b32 s7, s3, 1
  s_lshl_b32 s7, s7, 3
  s_lshr_b32 s42, s4, 1
  s_add_u32 s7, s7, s42
  v_and_b32 v3, 31, v1
  v_lshrrev_b32 v4, 5, v1
  s_lshl_b32 s42, s5, 8
  s_lshl_b32 s43, s6, 5
  s_add_u32 s43, s42, s43
  v_add_u32 v5, s43, v3
  v_lshrrev_b32 v7, 3, v1
  v_and_b32 v8, 7, v1
  v_lshrrev_b32 v6, 4, v1
  v_xor_b32 v8, v8, v6
  v_mul_u32_u24 v6, 896, v7
  v_xor_b32 v7, 4, v8
  v_lshl_add_u32 v239, v7, 4, v6
  v_lshl_add_u32 v6, v8, 4, v6
  s_mul_i32 s44, s43, 896
  v_bfe_u32 v7, v1, 2, 3
  v_mul_u32_u24 v7, 2688, v7
  v_and_b32 v8, 3, v1
  v_lshl_add_u32 v7, v8, 4, v7
  v_mul_u32_u24 v8, 896, v4
  s_mul_i32 s45, s7, 56
  v_add3_u32 v7, v7, v8, s45
  s_mul_i32 s48, s6, 21504
  s_mul_i32 s49, s6, 1536
  s_lshl_b32 s50, s6, 12
  v_min_u32 v30, 447, v0
  v_lshlrev_b32 v30, 1, v30
  s_lshr_b32 s51, s4, 1
  s_and_b32 s54, s4, 1
  s_mul_i32 s54, s54, 3
  s_add_u32 s51, s51, s54
  s_sub_u32 s54, s51, 7
  s_cmp_ge_u32 s51, 7
  s_cselect_b32 s51, s54, s51
  s_sub_u32 s54, s51, 7
  s_cmp_ge_u32 s51, 7
  s_cselect_b32 s88, s54, s51
  s_add_u32 s89, s88, 1
  s_cmp_ge_u32 s89, 7
  s_cselect_b32 s89, 0, s89
  s_add_u32 s90, s89, 1
  s_cmp_ge_u32 s90, 7
  s_cselect_b32 s90, 0, s90
  s_add_u32 s91, s90, 1
  s_cmp_ge_u32 s91, 7
  s_cselect_b32 s91, 0, s91
  s_add_u32 s92, s91, 1
  s_cmp_ge_u32 s92, 7
  s_cselect_b32 s92, 0, s92
  s_add_u32 s93, s92, 1
  s_cmp_ge_u32 s93, 7
  s_cselect_b32 s93, 0, s93
  s_add_u32 s94, s93, 1
  s_cmp_ge_u32 s94, 7
  s_cselect_b32 s94, 0, s94
  s_waitcnt lgkmcnt(0)
  s_mov_b32 s8, s36
  s_mov_b32 s9, s37
  s_mov_b32 s10, 1835008
  s_mov_b32 s11, 0x00020000
  s_mov_b32 s12, s34
  s_mov_b32 s13, s35
  s_mov_b32 s14, 16777216
  s_mov_b32 s15, 0x00020000
  s_mov_b32 s16, s38
  s_mov_b32 s17, s39
  s_mov_b32 s18, 1204224
  s_mov_b32 s19, 0x00020000
  s_mov_b32 s20, s40
  s_mov_b32 s21, s41
  s_mov_b32 s22, 25088
  s_mov_b32 s23, 0x00020000
  global_load_ushort v29, v30, s[24:25]
  s_mul_i32 s55, s88, 172032
  s_add_u32 s55, s55, s48
  s_add_u32 m0, s49, 32768
  s_add_u32 s51, s55, 1792
  buffer_load_dwordx4 v7, s[16:19], s55 offen lds
  s_add_u32 m0, s49, 33792
  s_mov_b32 exec_hi, 0
  buffer_load_dwordx4 v7, s[16:19], s51 offen lds
  s_mov_b32 exec_hi, -1
  s_add_u32 m0, s50, 0
  s_lshl_b32 s55, s88, 7
  s_add_u32 s55, s55, s44
  s_add_u32 s55, s55, 0
  buffer_load_dwordx4 v6, s[8:11], s55 offen lds
  s_add_u32 m0, s50, 1024
  s_lshl_b32 s55, s88, 7
  s_add_u32 s55, s55, s44
  s_add_u32 s55, s55, 7168
  buffer_load_dwordx4 v239, s[8:11], s55 offen lds
  s_add_u32 m0, s50, 2048
  s_lshl_b32 s55, s88, 7
  s_add_u32 s55, s55, s44
  s_add_u32 s55, s55, 14336
  buffer_load_dwordx4 v6, s[8:11], s55 offen lds
  s_add_u32 m0, s50, 3072
  s_lshl_b32 s55, s88, 7
  s_add_u32 s55, s55, s44
  s_add_u32 s55, s55, 21504
  buffer_load_dwordx4 v239, s[8:11], s55 offen lds
  s_or_b32 s51, s2, s6
  s_cmp_lg_u32 s51, 0
  s_cbranch_scc1 LA_notok
  s_memrealtime s[56:57]
  s_waitcnt lgkmcnt(0)
  s_or_b32 s56, s56, 1
  v_mov_b32 v2, s56
  v_mov_b32 v9, 0
  s_mov_b64 s[56:57], exec
  s_mov_b64 exec, 1
  global_store_dword v9, v2, s[32:33] sc1
  s_mov_b64 exec, s[56:57]
LA_notok:
  v_cmp_eq_u32 s[52:53], 1, v4
  v_mov_b32 v9, 1.0
  s_mov_b32 s47, 0x3fb8aa3b
  s_mov_b32 s46, 0x3fb8aa3b
  v_cndmask_b32 v9, v9, 0, s[52:53]
  v_lshlrev_b32 v31, 2, v4
  v_sub_u32 v31, v3, v31
  v_cmp_eq_u32 vcc, 0, v31
  v_cmp_eq_u32 s[54:55], 1, v31
  v_mov_b32 v2, 0x3f80
  v_mov_b32 v30, 0x3f800000
  v_cndmask_b32 v248, 0, v2, vcc
  v_cndmask_b32 v248, v248, v30, s[54:55]
  v_cmp_eq_u32 vcc, 2, v31
  v_cmp_eq_u32 s[54:55], 3, v31
  v_mov_b32 v2, 0x3f80
  v_mov_b32 v30, 0x3f800000
  v_cndmask_b32 v249, 0, v2, vcc
  v_cndmask_b32 v249, v249, v30, s[54:55]
  v_cmp_eq_u32 vcc, 8, v31
  v_cmp_eq_u32 s[54:55], 9, v31
  v_mov_b32 v2, 0x3f80
  v_mov_b32 v30, 0x3f800000
  v_cndmask_b32 v250, 0, v2, vcc
  v_cndmask_b32 v250, v250, v30, s[54:55]
  v_cmp_eq_u32 vcc, 10, v31
  v_cmp_eq_u32 s[54:55], 11, v31
  v_mov_b32 v2, 0x3f80
  v_mov_b32 v30, 0x3f800000
  v_cndmask_b32 v251, 0, v2, vcc
  v_cndmask_b32 v251, v251, v30, s[54:55]
  v_cmp_eq_u32 vcc, 16, v31
  v_cmp_eq_u32 s[54:55], 17, v31
  v_mov_b32 v2, 0x3f80
  v_mov_b32 v30, 0x3f800000
  v_cndmask_b32 v252, 0, v2, vcc
  v_cndmask_b32 v252, v252, v30, s[54:55]
  v_cmp_eq_u32 vcc, 18, v31
  v_cmp_eq_u32 s[54:55], 19, v31
  v_mov_b32 v2, 0x3f80
  v_mov_b32 v30, 0x3f800000
  v_cndmask_b32 v253, 0, v2, vcc
  v_cndmask_b32 v253, v253, v30, s[54:55]
  v_cmp_eq_u32 vcc, 24, v31
  v_cmp_eq_u32 s[54:55], 25, v31
  v_mov_b32 v2, 0x3f80
  v_mov_b32 v30, 0x3f800000
  v_cndmask_b32 v254, 0, v2, vcc
  v_cndmask_b32 v254, v254, v30, s[54:55]
  v_cmp_eq_u32 vcc, 26, v31
  v_cmp_eq_u32 s[54:55], 27, v31
  v_mov_b32 v2, 0x3f80
  v_mov_b32 v30, 0x3f800000
  v_cndmask_b32 v255, 0, v2, vcc
  v_cndmask_b32 v255, v255, v30, s[54:55]
  v_and_b32 v2, 15, v1
  v_lshrrev_b32 v8, 4, v1
  v_lshrrev_b32 v31, 1, v8
  v_mul_u32_u24 v31, 1536, v31
  v_lshrrev_b32 v28, 2, v2
  v_lshl_add_u32 v31, v28, 6, v31
  v_and_b32 v8, 1, v8
  v_lshl_add_u32 v31, v8, 5, v31
  v_and_b32 v2, 3, v2
  v_lshl_add_u32 v8, v2, 3, v31
  v_add_u32 v8, 32768, v8
  v_bfe_u32 v2, v3, 1, 3
  v_lshlrev_b32 v28, 7, v3
  v_add_u32 v28, s50, v28
  v_add_u32 v240, 0, v4
  v_xor_b32 v240, v240, v2
  v_lshl_add_u32 v240, v240, 4, v28
  v_add_u32 v241, 2, v4
  v_xor_b32 v241, v241, v2
  v_lshl_add_u32 v241, v241, 4, v28
  v_add_u32 v242, 4, v4
  v_xor_b32 v242, v242, v2
  v_lshl_add_u32 v242, v242, 4, v28
  v_add_u32 v243, 6, v4
  v_xor_b32 v243, v243, v2
  v_lshl_add_u32 v243, v243, 4, v28
  v_mov_b32 v32, 0
  v_mov_b32 v48, 0
  v_mov_b32 v192, 0
  v_mov_b32 v33, 0
  v_mov_b32 v49, 0
  v_mov_b32 v193, 0
  v_mov_b32 v34, 0
  v_mov_b32 v50, 0
  v_mov_b32 v194, 0
  v_mov_b32 v35, 0
  v_mov_b32 v51, 0
  v_mov_b32 v195, 0
  v_mov_b32 v36, 0
  v_mov_b32 v52, 0
  v_mov_b32 v196, 0
  v_mov_b32 v37, 0
  v_mov_b32 v53, 0
  v_mov_b32 v197, 0
  v_mov_b32 v38, 0
  v_mov_b32 v54, 0
  v_mov_b32 v198, 0
  v_mov_b32 v39, 0
  v_mov_b32 v55, 0
  v_mov_b32 v199, 0
  v_mov_b32 v40, 0
  v_mov_b32 v56, 0
  v_mov_b32 v200, 0
  v_mov_b32 v41, 0
  v_mov_b32 v57, 0
  v_mov_b32 v201, 0
  v_mov_b32 v42, 0
  v_mov_b32 v58, 0
  v_mov_b32 v202, 0
  v_mov_b32 v43, 0
  v_mov_b32 v59, 0
  v_mov_b32 v203, 0
  v_mov_b32 v44, 0
  v_mov_b32 v60, 0
  v_mov_b32 v204, 0
  v_mov_b32 v45, 0
  v_mov_b32 v61, 0
  v_mov_b32 v205, 0
  v_mov_b32 v46, 0
  v_mov_b32 v62, 0
  v_mov_b32 v206, 0
  v_mov_b32 v47, 0
  v_mov_b32 v63, 0
  v_mov_b32 v207, 0
  v_lshlrev_b32 v31, 4, v4
  v_add_u32 v31, 155648, v31
  s_mov_b32 s98, 0x20000000
  s_mov_b32 s99, 0x20000000
  s_waitcnt vmcnt(6)
  v_lshlrev_b32 v2, 1, v0
  v_add_u32 v2, 155648, v2
  v_cmp_gt_u32 vcc, 448, v0
  s_nop 0
  s_and_saveexec_b64 s[56:57], vcc
  ds_write_b16 v2, v29
  s_mov_b64 exec, s[56:57]
  s_waitcnt vmcnt(0) lgkmcnt(0)
  s_barrier
  s_mul_i32 s55, s89, 172032
  s_add_u32 s55, s55, s48
  s_add_u32 m0, s49, 77824
  s_add_u32 s51, s55, 1792
  buffer_load_dwordx4 v7, s[16:19], s55 offen lds
  s_add_u32 m0, s49, 78848
  s_mov_b32 exec_hi, 0
  buffer_load_dwordx4 v7, s[16:19], s51 offen lds
  s_mov_b32 exec_hi, -1
  s_add_u32 m0, s50, 45056
  s_lshl_b32 s55, s89, 7
  s_add_u32 s55, s55, s44
  s_add_u32 s55, s55, 0
  buffer_load_dwordx4 v6, s[8:11], s55 offen lds
  s_add_u32 m0, s50, 46080
  s_lshl_b32 s55, s89, 7
  s_add_u32 s55, s55, s44
  s_add_u32 s55, s55, 7168
  buffer_load_dwordx4 v239, s[8:11], s55 offen lds
  s_add_u32 m0, s50, 47104
  s_lshl_b32 s55, s89, 7
  s_add_u32 s55, s55, s44
  s_add_u32 s55, s55, 14336
  buffer_load_dwordx4 v6, s[8:11], s55 offen lds
  s_add_u32 m0, s50, 48128
  s_lshl_b32 s55, s89, 7
  s_add_u32 s55, s55, s44
  s_add_u32 s55, s55, 21504
  buffer_load_dwordx4 v239, s[8:11], s55 offen lds
  v_add_u32 v244, 0, v240
  v_add_u32 v245, 0, v241
  v_add_u32 v246, 0, v242
  v_add_u32 v247, 0, v243
  v_add_u32 v28, 0, v8
  s_lshl_b32 s51, s88, 7
  v_add_u32 v30, s51, v31
  ds_read_b128 v[64:67], v244
  ds_read_b64_tr_b16 v[80:81], v28 offset:0
  ds_read_b64_tr_b16 v[82:83], v28 offset:256
  ds_read_b64_tr_b16 v[96:97], v28 offset:512
  ds_read_b64_tr_b16 v[98:99], v28 offset:768
  ds_read_b64_tr_b16 v[112:113], v28 offset:1024
  ds_read_b64_tr_b16 v[114:115], v28 offset:1280
  ds_read_b128 v[68:71], v245
  ds_read_b64_tr_b16 v[84:85], v28 offset:3072
  ds_read_b64_tr_b16 v[86:87], v28 offset:3328
  ds_read_b64_tr_b16 v[100:101], v28 offset:3584
  ds_read_b64_tr_b16 v[102:103], v28 offset:3840
  ds_read_b64_tr_b16 v[116:117], v28 offset:4096
  ds_read_b64_tr_b16 v[118:119], v28 offset:4352
  ds_read_b128 v[72:75], v246
  ds_read_b64_tr_b16 v[88:89], v28 offset:6144
  ds_read_b64_tr_b16 v[90:91], v28 offset:6400
  ds_read_b64_tr_b16 v[104:105], v28 offset:6656
  ds_read_b64_tr_b16 v[106:107], v28 offset:6912
  ds_read_b64_tr_b16 v[120:121], v28 offset:7168
  ds_read_b64_tr_b16 v[122:123], v28 offset:7424
  ds_read_b128 v[76:79], v247
  ds_read_b64_tr_b16 v[92:93], v28 offset:9216
  ds_read_b64_tr_b16 v[94:95], v28 offset:9472
  ds_read_b64_tr_b16 v[108:109], v28 offset:9728
  ds_read_b64_tr_b16 v[110:111], v28 offset:9984
  ds_read_b64_tr_b16 v[124:125], v28 offset:10240
  ds_read_b64_tr_b16 v[126:127], v28 offset:10496
  s_mov_b64 exec, s[98:99]
  ds_read_b128 v[80:83], v30 offset:0
  ds_read_b128 v[84:87], v30 offset:32
  ds_read_b128 v[88:91], v30 offset:64
  ds_read_b128 v[92:95], v30 offset:96
  s_mov_b64 exec, -1
  s_mul_i32 s55, s90, 172032
  s_add_u32 s55, s55, s48
  s_add_u32 m0, s49, 122880
  s_add_u32 s51, s55, 1792
  buffer_load_dwordx4 v7, s[16:19], s55 offen lds
  s_add_u32 m0, s49, 123904
  s_mov_b32 exec_hi, 0
  buffer_load_dwordx4 v7, s[16:19], s51 offen lds
  s_mov_b32 exec_hi, -1
  s_add_u32 m0, s50, 90112
  s_lshl_b32 s55, s90, 7
  s_add_u32 s55, s55, s44
  s_add_u32 s55, s55, 0
  buffer_load_dwordx4 v6, s[8:11], s55 offen lds
  s_add_u32 m0, s50, 91136
  s_lshl_b32 s55, s90, 7
  s_add_u32 s55, s55, s44
  s_add_u32 s55, s55, 7168
  buffer_load_dwordx4 v239, s[8:11], s55 offen lds
  s_add_u32 m0, s50, 92160
  s_lshl_b32 s55, s90, 7
  s_add_u32 s55, s55, s44
  s_add_u32 s55, s55, 14336
  buffer_load_dwordx4 v6, s[8:11], s55 offen lds
  s_add_u32 m0, s50, 93184
  s_lshl_b32 s55, s90, 7
  s_add_u32 s55, s55, s44
  s_add_u32 s55, s55, 21504
  buffer_load_dwordx4 v239, s[8:11], s55 offen lds
  s_waitcnt lgkmcnt(0)
  s_waitcnt vmcnt(6)
  s_barrier
  v_mfma_f32_32x32x16_bf16 v[32:47], v[96:99], v[64:67], v[32:47]
  v_add_u32 v244, 45056, v240
  v_add_u32 v245, 45056, v241
  v_add_u32 v246, 45056, v242
  v_mfma_f32_32x32x16_bf16 v[48:63], v[64:67], v[112:115], v[48:63]
  v_add_u32 v247, 45056, v243
  v_add_u32 v28, 45056, v8
  s_lshl_b32 s51, s89, 7
  v_mfma_f32_32x32x16_bf16 v[192:207], v[80:83], v[64:67], v[192:207]
  v_add_u32 v30, s51, v31
  ds_read_b128 v[128:131], v244
  ds_read_b64_tr_b16 v[144:145], v28 offset:0
  v_mfma_f32_32x32x16_bf16 v[32:47], v[100:103], v[68:71], v[32:47]
  ds_read_b64_tr_b16 v[146:147], v28 offset:256
  ds_read_b64_tr_b16 v[160:161], v28 offset:512
  ds_read_b64_tr_b16 v[162:163], v28 offset:768
  v_mfma_f32_32x32x16_bf16 v[48:63], v[68:71], v[116:119], v[48:63]
  ds_read_b64_tr_b16 v[176:177], v28 offset:1024
  ds_read_b64_tr_b16 v[178:179], v28 offset:1280
  ds_read_b128 v[132:135], v245
  v_mfma_f32_32x32x16_bf16 v[192:207], v[84:87], v[68:71], v[192:207]
  ds_read_b64_tr_b16 v[148:149], v28 offset:3072
  ds_read_b64_tr_b16 v[150:151], v28 offset:3328
  ds_read_b64_tr_b16 v[164:165], v28 offset:3584
  v_mfma_f32_32x32x16_bf16 v[32:47], v[104:107], v[72:75], v[32:47]
  ds_read_b64_tr_b16 v[166:167], v28 offset:3840
  ds_read_b64_tr_b16 v[180:181], v28 offset:4096
  ds_read_b64_tr_b16 v[182:183], v28 offset:4352
  v_mfma_f32_32x32x16_bf16 v[48:63], v[72:75], v[120:123], v[48:63]
  ds_read_b128 v[136:139], v246
  ds_read_b64_tr_b16 v[152:153], v28 offset:6144
  ds_read_b64_tr_b16 v[154:155], v28 offset:6400
  v_mfma_f32_32x32x16_bf16 v[192:207], v[88:91], v[72:75], v[192:207]
  ds_read_b64_tr_b16 v[168:169], v28 offset:6656
  ds_read_b64_tr_b16 v[170:171], v28 offset:6912
  ds_read_b64_tr_b16 v[184:185], v28 offset:7168
  v_mfma_f32_32x32x16_bf16 v[32:47], v[108:111], v[76:79], v[32:47]
  ds_read_b64_tr_b16 v[186:187], v28 offset:7424
  ds_read_b128 v[140:143], v247
  ds_read_b64_tr_b16 v[156:157], v28 offset:9216
  v_mfma_f32_32x32x16_bf16 v[48:63], v[76:79], v[124:127], v[48:63]
  ds_read_b64_tr_b16 v[158:159], v28 offset:9472
  ds_read_b64_tr_b16 v[172:173], v28 offset:9728
  ds_read_b64_tr_b16 v[174:175], v28 offset:9984
  v_mfma_f32_32x32x16_bf16 v[192:207], v[92:95], v[76:79], v[192:207]
  ds_read_b64_tr_b16 v[188:189], v28 offset:10240
  ds_read_b64_tr_b16 v[190:191], v28 offset:10496
  s_mov_b64 exec, s[98:99]
  ds_read_b128 v[144:147], v30 offset:0
  ds_read_b128 v[148:151], v30 offset:32
  ds_read_b128 v[152:155], v30 offset:64
  ds_read_b128 v[156:159], v30 offset:96
  s_mov_b64 exec, -1
  s_mul_i32 s55, s91, 172032
  s_add_u32 s55, s55, s48
  s_add_u32 m0, s49, 32768
  s_add_u32 s51, s55, 1792
  buffer_load_dwordx4 v7, s[16:19], s55 offen lds
  s_add_u32 m0, s49, 33792
  s_mov_b32 exec_hi, 0
  buffer_load_dwordx4 v7, s[16:19], s51 offen lds
  s_mov_b32 exec_hi, -1
  s_add_u32 m0, s50, 0
  s_lshl_b32 s55, s91, 7
  s_add_u32 s55, s55, s44
  s_add_u32 s55, s55, 0
  buffer_load_dwordx4 v6, s[8:11], s55 offen lds
  s_add_u32 m0, s50, 1024
  s_lshl_b32 s55, s91, 7
  s_add_u32 s55, s55, s44
  s_add_u32 s55, s55, 7168
  buffer_load_dwordx4 v239, s[8:11], s55 offen lds
  s_add_u32 m0, s50, 2048
  s_lshl_b32 s55, s91, 7
  s_add_u32 s55, s55, s44
  s_add_u32 s55, s55, 14336
  buffer_load_dwordx4 v6, s[8:11], s55 offen lds
  s_add_u32 m0, s50, 3072
  s_lshl_b32 s55, s91, 7
  s_add_u32 s55, s55, s44
  s_add_u32 s55, s55, 21504
  buffer_load_dwordx4 v239, s[8:11], s55 offen lds
  s_waitcnt lgkmcnt(0)
  s_waitcnt vmcnt(6)
  s_barrier
  v_mfma_f32_32x32x16_bf16 v[32:47], v[160:163], v[128:131], v[32:47]
  v_add_u32 v244, 90112, v240
  v_add_u32 v245, 90112, v241
  v_add_u32 v246, 90112, v242
  v_mfma_f32_32x32x16_bf16 v[48:63], v[128:131], v[176:179], v[48:63]
  v_add_u32 v247, 90112, v243
  v_add_u32 v28, 90112, v8
  s_lshl_b32 s51, s90, 7
  v_mfma_f32_32x32x16_bf16 v[192:207], v[144:147], v[128:131], v[192:207]
  v_add_u32 v30, s51, v31
  ds_read_b128 v[64:67], v244
  ds_read_b64_tr_b16 v[80:81], v28 offset:0
  v_mfma_f32_32x32x16_bf16 v[32:47], v[164:167], v[132:135], v[32:47]
  ds_read_b64_tr_b16 v[82:83], v28 offset:256
  ds_read_b64_tr_b16 v[96:97], v28 offset:512
  ds_read_b64_tr_b16 v[98:99], v28 offset:768
  v_mfma_f32_32x32x16_bf16 v[48:63], v[132:135], v[180:183], v[48:63]
  ds_read_b64_tr_b16 v[112:113], v28 offset:1024
  ds_read_b64_tr_b16 v[114:115], v28 offset:1280
  ds_read_b128 v[68:71], v245
  v_mfma_f32_32x32x16_bf16 v[192:207], v[148:151], v[132:135], v[192:207]
  ds_read_b64_tr_b16 v[84:85], v28 offset:3072
  ds_read_b64_tr_b16 v[86:87], v28 offset:3328
  ds_read_b64_tr_b16 v[100:101], v28 offset:3584
  v_mfma_f32_32x32x16_bf16 v[32:47], v[168:171], v[136:139], v[32:47]
  ds_read_b64_tr_b16 v[102:103], v28 offset:3840
  ds_read_b64_tr_b16 v[116:117], v28 offset:4096
  ds_read_b64_tr_b16 v[118:119], v28 offset:4352
  v_mfma_f32_32x32x16_bf16 v[48:63], v[136:139], v[184:187], v[48:63]
  ds_read_b128 v[72:75], v246
  ds_read_b64_tr_b16 v[88:89], v28 offset:6144
  ds_read_b64_tr_b16 v[90:91], v28 offset:6400
  v_mfma_f32_32x32x16_bf16 v[192:207], v[152:155], v[136:139], v[192:207]
  ds_read_b64_tr_b16 v[104:105], v28 offset:6656
  ds_read_b64_tr_b16 v[106:107], v28 offset:6912
  ds_read_b64_tr_b16 v[120:121], v28 offset:7168
  v_mfma_f32_32x32x16_bf16 v[32:47], v[172:175], v[140:143], v[32:47]
  ds_read_b64_tr_b16 v[122:123], v28 offset:7424
  ds_read_b128 v[76:79], v247
  ds_read_b64_tr_b16 v[92:93], v28 offset:9216
  v_mfma_f32_32x32x16_bf16 v[48:63], v[140:143], v[188:191], v[48:63]
  ds_read_b64_tr_b16 v[94:95], v28 offset:9472
  ds_read_b64_tr_b16 v[108:109], v28 offset:9728
  ds_read_b64_tr_b16 v[110:111], v28 offset:9984
  v_mfma_f32_32x32x16_bf16 v[192:207], v[156:159], v[140:143], v[192:207]
  ds_read_b64_tr_b16 v[124:125], v28 offset:10240
  ds_read_b64_tr_b16 v[126:127], v28 offset:10496
  s_mov_b64 exec, s[98:99]
  ds_read_b128 v[80:83], v30 offset:0
  ds_read_b128 v[84:87], v30 offset:32
  ds_read_b128 v[88:91], v30 offset:64
  ds_read_b128 v[92:95], v30 offset:96
  s_mov_b64 exec, -1
  s_mul_i32 s55, s92, 172032
  s_add_u32 s55, s55, s48
  s_add_u32 m0, s49, 77824
  s_add_u32 s51, s55, 1792
  buffer_load_dwordx4 v7, s[16:19], s55 offen lds
  s_add_u32 m0, s49, 78848
  s_mov_b32 exec_hi, 0
  buffer_load_dwordx4 v7, s[16:19], s51 offen lds
  s_mov_b32 exec_hi, -1
  s_add_u32 m0, s50, 45056
  s_lshl_b32 s55, s92, 7
  s_add_u32 s55, s55, s44
  s_add_u32 s55, s55, 0
  buffer_load_dwordx4 v6, s[8:11], s55 offen lds
  s_add_u32 m0, s50, 46080
  s_lshl_b32 s55, s92, 7
  s_add_u32 s55, s55, s44
  s_add_u32 s55, s55, 7168
  buffer_load_dwordx4 v239, s[8:11], s55 offen lds
  s_add_u32 m0, s50, 47104
  s_lshl_b32 s55, s92, 7
  s_add_u32 s55, s55, s44
  s_add_u32 s55, s55, 14336
  buffer_load_dwordx4 v6, s[8:11], s55 offen lds
  s_add_u32 m0, s50, 48128
  s_lshl_b32 s55, s92, 7
  s_add_u32 s55, s55, s44
  s_add_u32 s55, s55, 21504
  buffer_load_dwordx4 v239, s[8:11], s55 offen lds
  s_waitcnt lgkmcnt(0)
  s_waitcnt vmcnt(6)
  s_barrier
  v_mfma_f32_32x32x16_bf16 v[32:47], v[96:99], v[64:67], v[32:47]
  v_add_u32 v244, 0, v240
  v_add_u32 v245, 0, v241
  v_add_u32 v246, 0, v242
  v_mfma_f32_32x32x16_bf16 v[48:63], v[64:67], v[112:115], v[48:63]
  v_add_u32 v247, 0, v243
  v_add_u32 v28, 0, v8
  s_lshl_b32 s51, s91, 7
  v_mfma_f32_32x32x16_bf16 v[192:207], v[80:83], v[64:67], v[192:207]
  v_add_u32 v30, s51, v31
  ds_read_b128 v[128:131], v244
  ds_read_b64_tr_b16 v[144:145], v28 offset:0
  v_mfma_f32_32x32x16_bf16 v[32:47], v[100:103], v[68:71], v[32:47]
  ds_read_b64_tr_b16 v[146:147], v28 offset:256
  ds_read_b64_tr_b16 v[160:161], v28 offset:512
  ds_read_b64_tr_b16 v[162:163], v28 offset:768
  v_mfma_f32_32x32x16_bf16 v[48:63], v[68:71], v[116:119], v[48:63]
  ds_read_b64_tr_b16 v[176:177], v28 offset:1024
  ds_read_b64_tr_b16 v[178:179], v28 offset:1280
  ds_read_b128 v[132:135], v245
  v_mfma_f32_32x32x16_bf16 v[192:207], v[84:87], v[68:71], v[192:207]
  ds_read_b64_tr_b16 v[148:149], v28 offset:3072
  ds_read_b64_tr_b16 v[150:151], v28 offset:3328
  ds_read_b64_tr_b16 v[164:165], v28 offset:3584
  v_mfma_f32_32x32x16_bf16 v[32:47], v[104:107], v[72:75], v[32:47]
  ds_read_b64_tr_b16 v[166:167], v28 offset:3840
  ds_read_b64_tr_b16 v[180:181], v28 offset:4096
  ds_read_b64_tr_b16 v[182:183], v28 offset:4352
  v_mfma_f32_32x32x16_bf16 v[48:63], v[72:75], v[120:123], v[48:63]
  ds_read_b128 v[136:139], v246
  ds_read_b64_tr_b16 v[152:153], v28 offset:6144
  ds_read_b64_tr_b16 v[154:155], v28 offset:6400
  v_mfma_f32_32x32x16_bf16 v[192:207], v[88:91], v[72:75], v[192:207]
  ds_read_b64_tr_b16 v[168:169], v28 offset:6656
  ds_read_b64_tr_b16 v[170:171], v28 offset:6912
  ds_read_b64_tr_b16 v[184:185], v28 offset:7168
  v_mfma_f32_32x32x16_bf16 v[32:47], v[108:111], v[76:79], v[32:47]
  ds_read_b64_tr_b16 v[186:187], v28 offset:7424
  ds_read_b128 v[140:143], v247
  ds_read_b64_tr_b16 v[156:157], v28 offset:9216
  v_mfma_f32_32x32x16_bf16 v[48:63], v[76:79], v[124:127], v[48:63]
  ds_read_b64_tr_b16 v[158:159], v28 offset:9472
  ds_read_b64_tr_b16 v[172:173], v28 offset:9728
  ds_read_b64_tr_b16 v[174:175], v28 offset:9984
  v_mfma_f32_32x32x16_bf16 v[192:207], v[92:95], v[76:79], v[192:207]
  ds_read_b64_tr_b16 v[188:189], v28 offset:10240
  ds_read_b64_tr_b16 v[190:191], v28 offset:10496
  s_mov_b64 exec, s[98:99]
  ds_read_b128 v[144:147], v30 offset:0
  ds_read_b128 v[148:151], v30 offset:32
  ds_read_b128 v[152:155], v30 offset:64
  ds_read_b128 v[156:159], v30 offset:96
  s_mov_b64 exec, -1
  s_mul_i32 s55, s93, 172032
  s_add_u32 s55, s55, s48
  s_add_u32 m0, s49, 122880
  s_add_u32 s51, s55, 1792
  buffer_load_dwordx4 v7, s[16:19], s55 offen lds
  s_add_u32 m0, s49, 123904
  s_mov_b32 exec_hi, 0
  buffer_load_dwordx4 v7, s[16:19], s51 offen lds
  s_mov_b32 exec_hi, -1
  s_add_u32 m0, s50, 90112
  s_lshl_b32 s55, s93, 7
  s_add_u32 s55, s55, s44
  s_add_u32 s55, s55, 0
  buffer_load_dwordx4 v6, s[8:11], s55 offen lds
  s_add_u32 m0, s50, 91136
  s_lshl_b32 s55, s93, 7
  s_add_u32 s55, s55, s44
  s_add_u32 s55, s55, 7168
  buffer_load_dwordx4 v239, s[8:11], s55 offen lds
  s_add_u32 m0, s50, 92160
  s_lshl_b32 s55, s93, 7
  s_add_u32 s55, s55, s44
  s_add_u32 s55, s55, 14336
  buffer_load_dwordx4 v6, s[8:11], s55 offen lds
  s_add_u32 m0, s50, 93184
  s_lshl_b32 s55, s93, 7
  s_add_u32 s55, s55, s44
  s_add_u32 s55, s55, 21504
  buffer_load_dwordx4 v239, s[8:11], s55 offen lds
  s_waitcnt lgkmcnt(0)
  s_waitcnt vmcnt(6)
  s_barrier
  v_mfma_f32_32x32x16_bf16 v[32:47], v[160:163], v[128:131], v[32:47]
  v_add_u32 v244, 45056, v240
  v_add_u32 v245, 45056, v241
  v_add_u32 v246, 45056, v242
  v_mfma_f32_32x32x16_bf16 v[48:63], v[128:131], v[176:179], v[48:63]
  v_add_u32 v247, 45056, v243
  v_add_u32 v28, 45056, v8
  s_lshl_b32 s51, s92, 7
  v_mfma_f32_32x32x16_bf16 v[192:207], v[144:147], v[128:131], v[192:207]
  v_add_u32 v30, s51, v31
  ds_read_b128 v[64:67], v244
  ds_read_b64_tr_b16 v[80:81], v28 offset:0
  v_mfma_f32_32x32x16_bf16 v[32:47], v[164:167], v[132:135], v[32:47]
  ds_read_b64_tr_b16 v[82:83], v28 offset:256
  ds_read_b64_tr_b16 v[96:97], v28 offset:512
  ds_read_b64_tr_b16 v[98:99], v28 offset:768
  v_mfma_f32_32x32x16_bf16 v[48:63], v[132:135], v[180:183], v[48:63]
  ds_read_b64_tr_b16 v[112:113], v28 offset:1024
  ds_read_b64_tr_b16 v[114:115], v28 offset:1280
  ds_read_b128 v[68:71], v245
  v_mfma_f32_32x32x16_bf16 v[192:207], v[148:151], v[132:135], v[192:207]
  ds_read_b64_tr_b16 v[84:85], v28 offset:3072
  ds_read_b64_tr_b16 v[86:87], v28 offset:3328
  ds_read_b64_tr_b16 v[100:101], v28 offset:3584
  v_mfma_f32_32x32x16_bf16 v[32:47], v[168:171], v[136:139], v[32:47]
  ds_read_b64_tr_b16 v[102:103], v28 offset:3840
  ds_read_b64_tr_b16 v[116:117], v28 offset:4096
  ds_read_b64_tr_b16 v[118:119], v28 offset:4352
  v_mfma_f32_32x32x16_bf16 v[48:63], v[136:139], v[184:187], v[48:63]
  ds_read_b128 v[72:75], v246
  ds_read_b64_tr_b16 v[88:89], v28 offset:6144
  ds_read_b64_tr_b16 v[90:91], v28 offset:6400
  v_mfma_f32_32x32x16_bf16 v[192:207], v[152:155], v[136:139], v[192:207]
  ds_read_b64_tr_b16 v[104:105], v28 offset:6656
  ds_read_b64_tr_b16 v[106:107], v28 offset:6912
  ds_read_b64_tr_b16 v[120:121], v28 offset:7168
  v_mfma_f32_32x32x16_bf16 v[32:47], v[172:175], v[140:143], v[32:47]
  ds_read_b64_tr_b16 v[122:123], v28 offset:7424
  ds_read_b128 v[76:79], v247
  ds_read_b64_tr_b16 v[92:93], v28 offset:9216
  v_mfma_f32_32x32x16_bf16 v[48:63], v[140:143], v[188:191], v[48:63]
  ds_read_b64_tr_b16 v[94:95], v28 offset:9472
  ds_read_b64_tr_b16 v[108:109], v28 offset:9728
  ds_read_b64_tr_b16 v[110:111], v28 offset:9984
  v_mfma_f32_32x32x16_bf16 v[192:207], v[156:159], v[140:143], v[192:207]
  ds_read_b64_tr_b16 v[124:125], v28 offset:10240
  ds_read_b64_tr_b16 v[126:127], v28 offset:10496
  s_mov_b64 exec, s[98:99]
  ds_read_b128 v[80:83], v30 offset:0
  ds_read_b128 v[84:87], v30 offset:32
  ds_read_b128 v[88:91], v30 offset:64
  ds_read_b128 v[92:95], v30 offset:96
  s_mov_b64 exec, -1
  s_mul_i32 s55, s94, 172032
  s_add_u32 s55, s55, s48
  s_add_u32 m0, s49, 32768
  s_add_u32 s51, s55, 1792
  buffer_load_dwordx4 v7, s[16:19], s55 offen lds
  s_add_u32 m0, s49, 33792
  s_mov_b32 exec_hi, 0
  buffer_load_dwordx4 v7, s[16:19], s51 offen lds
  s_mov_b32 exec_hi, -1
  s_add_u32 m0, s50, 0
  s_lshl_b32 s55, s94, 7
  s_add_u32 s55, s55, s44
  s_add_u32 s55, s55, 0
  buffer_load_dwordx4 v6, s[8:11], s55 offen lds
  s_add_u32 m0, s50, 1024
  s_lshl_b32 s55, s94, 7
  s_add_u32 s55, s55, s44
  s_add_u32 s55, s55, 7168
  buffer_load_dwordx4 v239, s[8:11], s55 offen lds
  s_add_u32 m0, s50, 2048
  s_lshl_b32 s55, s94, 7
  s_add_u32 s55, s55, s44
  s_add_u32 s55, s55, 14336
  buffer_load_dwordx4 v6, s[8:11], s55 offen lds
  s_add_u32 m0, s50, 3072
  s_lshl_b32 s55, s94, 7
  s_add_u32 s55, s55, s44
  s_add_u32 s55, s55, 21504
  buffer_load_dwordx4 v239, s[8:11], s55 offen lds
  s_waitcnt lgkmcnt(0)
  s_waitcnt vmcnt(6)
  s_barrier
  v_mfma_f32_32x32x16_bf16 v[32:47], v[96:99], v[64:67], v[32:47]
  v_add_u32 v244, 90112, v240
  v_add_u32 v245, 90112, v241
  v_add_u32 v246, 90112, v242
  v_mfma_f32_32x32x16_bf16 v[48:63], v[64:67], v[112:115], v[48:63]
  v_add_u32 v247, 90112, v243
  v_add_u32 v28, 90112, v8
  s_lshl_b32 s51, s93, 7
  v_mfma_f32_32x32x16_bf16 v[192:207], v[80:83], v[64:67], v[192:207]
  v_add_u32 v30, s51, v31
  ds_read_b128 v[128:131], v244
  ds_read_b64_tr_b16 v[144:145], v28 offset:0
  v_mfma_f32_32x32x16_bf16 v[32:47], v[100:103], v[68:71], v[32:47]
  ds_read_b64_tr_b16 v[146:147], v28 offset:256
  ds_read_b64_tr_b16 v[160:161], v28 offset:512
  ds_read_b64_tr_b16 v[162:163], v28 offset:768
  v_mfma_f32_32x32x16_bf16 v[48:63], v[68:71], v[116:119], v[48:63]
  ds_read_b64_tr_b16 v[176:177], v28 offset:1024
  ds_read_b64_tr_b16 v[178:179], v28 offset:1280
  ds_read_b128 v[132:135], v245
  v_mfma_f32_32x32x16_bf16 v[192:207], v[84:87], v[68:71], v[192:207]
  ds_read_b64_tr_b16 v[148:149], v28 offset:3072
  ds_read_b64_tr_b16 v[150:151], v28 offset:3328
  ds_read_b64_tr_b16 v[164:165], v28 offset:3584
  v_mfma_f32_32x32x16_bf16 v[32:47], v[104:107], v[72:75], v[32:47]
  ds_read_b64_tr_b16 v[166:167], v28 offset:3840
  ds_read_b64_tr_b16 v[180:181], v28 offset:4096
  ds_read_b64_tr_b16 v[182:183], v28 offset:4352
  v_mfma_f32_32x32x16_bf16 v[48:63], v[72:75], v[120:123], v[48:63]
  ds_read_b128 v[136:139], v246
  ds_read_b64_tr_b16 v[152:153], v28 offset:6144
  ds_read_b64_tr_b16 v[154:155], v28 offset:6400
  v_mfma_f32_32x32x16_bf16 v[192:207], v[88:91], v[72:75], v[192:207]
  ds_read_b64_tr_b16 v[168:169], v28 offset:6656
  ds_read_b64_tr_b16 v[170:171], v28 offset:6912
  ds_read_b64_tr_b16 v[184:185], v28 offset:7168
  v_mfma_f32_32x32x16_bf16 v[32:47], v[108:111], v[76:79], v[32:47]
  ds_read_b64_tr_b16 v[186:187], v28 offset:7424
  ds_read_b128 v[140:143], v247
  ds_read_b64_tr_b16 v[156:157], v28 offset:9216
  v_mfma_f32_32x32x16_bf16 v[48:63], v[76:79], v[124:127], v[48:63]
  ds_read_b64_tr_b16 v[158:159], v28 offset:9472
  ds_read_b64_tr_b16 v[172:173], v28 offset:9728
  ds_read_b64_tr_b16 v[174:175], v28 offset:9984
  v_mfma_f32_32x32x16_bf16 v[192:207], v[92:95], v[76:79], v[192:207]
  ds_read_b64_tr_b16 v[188:189], v28 offset:10240
  ds_read_b64_tr_b16 v[190:191], v28 offset:10496
  s_mov_b64 exec, s[98:99]
  ds_read_b128 v[144:147], v30 offset:0
  ds_read_b128 v[148:151], v30 offset:32
  ds_read_b128 v[152:155], v30 offset:64
  ds_read_b128 v[156:159], v30 offset:96
  s_mov_b64 exec, -1
  v_cmp_lt_u32 vcc, 27, v3
  v_subrev_u32 v10, 4, v3
  s_mul_i32 s51, s7, 1568
  s_nop 0
  v_cndmask_b32 v10, v3, v10, vcc
  v_lshlrev_b32 v10, 1, v10
  v_mul_u32_u24 v11, 224, v4
  v_add3_u32 v10, v10, v11, s51
  v_mov_b32 v11, 0x40000000
  v_cndmask_b32 v11, v10, v11, s[52:53]
  buffer_load_ushort v12, v10, s[20:23], 0 offen offset:0
  buffer_load_ushort v13, v10, s[20:23], 0 offen offset:56
  buffer_load_ushort v14, v10, s[20:23], 0 offen offset:112
  buffer_load_ushort v15, v10, s[20:23], 0 offen offset:168
  buffer_load_ushort v16, v10, s[20:23], 0 offen offset:448
  buffer_load_ushort v17, v10, s[20:23], 0 offen offset:504
  buffer_load_ushort v18, v10, s[20:23], 0 offen offset:560
  buffer_load_ushort v19, v10, s[20:23], 0 offen offset:616
  buffer_load_ushort v20, v10, s[20:23], 0 offen offset:896
  buffer_load_ushort v21, v10, s[20:23], 0 offen offset:952
  buffer_load_ushort v22, v10, s[20:23], 0 offen offset:1008
  buffer_load_ushort v23, v10, s[20:23], 0 offen offset:1064
  buffer_load_ushort v24, v11, s[20:23], 0 offen offset:1344
  buffer_load_ushort v25, v11, s[20:23], 0 offen offset:1400
  buffer_load_ushort v26, v11, s[20:23], 0 offen offset:1456
  buffer_load_ushort v27, v11, s[20:23], 0 offen offset:1512
  s_waitcnt lgkmcnt(0)
  s_waitcnt vmcnt(16)
  s_barrier
  v_mfma_f32_32x32x16_bf16 v[32:47], v[160:163], v[128:131], v[32:47]
  v_add_u32 v244, 0, v240
  v_add_u32 v245, 0, v241
  v_add_u32 v246, 0, v242
  v_mfma_f32_32x32x16_bf16 v[48:63], v[128:131], v[176:179], v[48:63]
  v_add_u32 v247, 0, v243
  v_add_u32 v28, 0, v8
  s_lshl_b32 s51, s94, 7
  v_mfma_f32_32x32x16_bf16 v[192:207], v[144:147], v[128:131], v[192:207]
  v_add_u32 v30, s51, v31
  ds_read_b128 v[64:67], v244
  ds_read_b64_tr_b16 v[80:81], v28 offset:0
  v_mfma_f32_32x32x16_bf16 v[32:47], v[164:167], v[132:135], v[32:47]
  ds_read_b64_tr_b16 v[82:83], v28 offset:256
  ds_read_b64_tr_b16 v[96:97], v28 offset:512
  ds_read_b64_tr_b16 v[98:99], v28 offset:768
  v_mfma_f32_32x32x16_bf16 v[48:63], v[132:135], v[180:183], v[48:63]
  ds_read_b64_tr_b16 v[112:113], v28 offset:1024
  ds_read_b64_tr_b16 v[114:115], v28 offset:1280
  ds_read_b128 v[68:71], v245
  v_mfma_f32_32x32x16_bf16 v[192:207], v[148:151], v[132:135], v[192:207]
  ds_read_b64_tr_b16 v[84:85], v28 offset:3072
  ds_read_b64_tr_b16 v[86:87], v28 offset:3328
  ds_read_b64_tr_b16 v[100:101], v28 offset:3584
  v_mfma_f32_32x32x16_bf16 v[32:47], v[168:171], v[136:139], v[32:47]
  ds_read_b64_tr_b16 v[102:103], v28 offset:3840
  ds_read_b64_tr_b16 v[116:117], v28 offset:4096
  ds_read_b64_tr_b16 v[118:119], v28 offset:4352
  v_mfma_f32_32x32x16_bf16 v[48:63], v[136:139], v[184:187], v[48:63]
  ds_read_b128 v[72:75], v246
  ds_read_b64_tr_b16 v[88:89], v28 offset:6144
  ds_read_b64_tr_b16 v[90:91], v28 offset:6400
  v_mfma_f32_32x32x16_bf16 v[192:207], v[152:155], v[136:139], v[192:207]
  ds_read_b64_tr_b16 v[104:105], v28 offset:6656
  ds_read_b64_tr_b16 v[106:107], v28 offset:6912
  ds_read_b64_tr_b16 v[120:121], v28 offset:7168
  v_mfma_f32_32x32x16_bf16 v[32:47], v[172:175], v[140:143], v[32:47]
  ds_read_b64_tr_b16 v[122:123], v28 offset:7424
  ds_read_b128 v[76:79], v247
  ds_read_b64_tr_b16 v[92:93], v28 offset:9216
  v_mfma_f32_32x32x16_bf16 v[48:63], v[140:143], v[188:191], v[48:63]
  ds_read_b64_tr_b16 v[94:95], v28 offset:9472
  ds_read_b64_tr_b16 v[108:109], v28 offset:9728
  ds_read_b64_tr_b16 v[110:111], v28 offset:9984
  v_mfma_f32_32x32x16_bf16 v[192:207], v[156:159], v[140:143], v[192:207]
  ds_read_b64_tr_b16 v[124:125], v28 offset:10240
  ds_read_b64_tr_b16 v[126:127], v28 offset:10496
  s_mov_b64 exec, s[98:99]
  ds_read_b128 v[80:83], v30 offset:0
  ds_read_b128 v[84:87], v30 offset:32
  ds_read_b128 v[88:91], v30 offset:64
  ds_read_b128 v[92:95], v30 offset:96
  s_mov_b64 exec, -1
  s_waitcnt lgkmcnt(0)
  v_mfma_f32_32x32x16_bf16 v[32:47], v[96:99], v[64:67], v[32:47]
  v_mfma_f32_32x32x16_bf16 v[48:63], v[64:67], v[112:115], v[48:63]
  v_mfma_f32_32x32x16_bf16 v[192:207], v[80:83], v[64:67], v[192:207]
  v_mfma_f32_32x32x16_bf16 v[32:47], v[100:103], v[68:71], v[32:47]
  v_mfma_f32_32x32x16_bf16 v[48:63], v[68:71], v[116:119], v[48:63]
  v_mfma_f32_32x32x16_bf16 v[192:207], v[84:87], v[68:71], v[192:207]
  v_mfma_f32_32x32x16_bf16 v[32:47], v[104:107], v[72:75], v[32:47]
  v_mfma_f32_32x32x16_bf16 v[48:63], v[72:75], v[120:123], v[48:63]
  v_mfma_f32_32x32x16_bf16 v[192:207], v[88:91], v[72:75], v[192:207]
  v_mfma_f32_32x32x16_bf16 v[32:47], v[108:111], v[76:79], v[32:47]
  v_mfma_f32_32x32x16_bf16 v[48:63], v[76:79], v[124:127], v[48:63]
  v_mfma_f32_32x32x16_bf16 v[192:207], v[92:95], v[76:79], v[192:207]
  v_mov_b32 v31, 0
  global_load_dword v31, v31, s[32:33] sc1
  s_waitcnt vmcnt(1)
  v_lshl_or_b32 v240, v13, 16, v12
  v_lshl_or_b32 v241, v15, 16, v14
  v_lshl_or_b32 v242, v17, 16, v16
  v_lshl_or_b32 v243, v19, 16, v18
  v_lshl_or_b32 v244, v21, 16, v20
  v_lshl_or_b32 v245, v23, 16, v22
  v_lshl_or_b32 v246, v25, 16, v24
  v_lshl_or_b32 v247, v27, 16, v26
  v_cvt_pk_bf16_f32 v64, v32, v33
  v_cvt_pk_bf16_f32 v65, v34, v35
  v_cvt_pk_bf16_f32 v66, v36, v37
  v_cvt_pk_bf16_f32 v67, v38, v39
  v_cvt_pk_bf16_f32 v68, v40, v41
  v_cvt_pk_bf16_f32 v69, v42, v43
  v_cvt_pk_bf16_f32 v70, v44, v45
  v_cvt_pk_bf16_f32 v71, v46, v47
  v_mfma_f32_32x32x16_bf16 v[72:87], v[240:243], v[64:67], 0
  s_nop 0
  v_mfma_f32_32x32x16_bf16 v[72:87], v[244:247], v[68:71], v[72:87]
  v_cmp_eq_u32 s[54:55], 28, v3
  v_mov_b32 v2, 0x3f803f80
  v_cvt_pk_bf16_f32 v12, v48, v49
  v_cvt_pk_bf16_f32 v13, v50, v51
  v_cvt_pk_bf16_f32 v14, v52, v53
  v_cvt_pk_bf16_f32 v15, v54, v55
  v_cvt_pk_bf16_f32 v16, v56, v57
  v_cvt_pk_bf16_f32 v17, v58, v59
  v_cvt_pk_bf16_f32 v18, v60, v61
  v_cvt_pk_bf16_f32 v19, v62, v63
  v_cndmask_b32 v12, v12, v2, s[54:55]
  v_cndmask_b32 v13, v13, v2, s[54:55]
  v_cndmask_b32 v14, v14, v2, s[54:55]
  v_cndmask_b32 v15, v15, v2, s[54:55]
  v_cndmask_b32 v16, v16, v2, s[54:55]
  v_cndmask_b32 v17, v17, v2, s[54:55]
  v_cndmask_b32 v18, v18, v2, s[54:55]
  v_cndmask_b32 v19, v19, v2, s[54:55]
  v_cvt_pk_bf16_f32 v88, v72, v73
  v_cvt_pk_bf16_f32 v89, v74, v75
  v_cvt_pk_bf16_f32 v90, v76, v77
  v_cvt_pk_bf16_f32 v91, v78, v79
  v_cvt_pk_bf16_f32 v92, v80, v81
  v_cvt_pk_bf16_f32 v93, v82, v83
  v_cvt_pk_bf16_f32 v94, v84, v85
  v_cvt_pk_bf16_f32 v95, v86, v87
  v_lshlrev_b32 v72, 16, v88
  v_and_b32 v73, 0xffff0000, v88
  v_lshlrev_b32 v74, 16, v89
  v_and_b32 v75, 0xffff0000, v89
  v_lshlrev_b32 v76, 16, v90
  v_and_b32 v77, 0xffff0000, v90
  v_lshlrev_b32 v78, 16, v91
  v_and_b32 v79, 0xffff0000, v91
  v_lshlrev_b32 v80, 16, v92
  v_and_b32 v81, 0xffff0000, v92
  v_lshlrev_b32 v82, 16, v93
  v_and_b32 v83, 0xffff0000, v93
  v_lshlrev_b32 v84, 16, v94
  v_and_b32 v85, 0xffff0000, v94
  v_lshlrev_b32 v86, 16, v95
  v_and_b32 v87, 0xffff0000, v95
  v_max3_f32 v120, v72, v73, v74
  v_min3_f32 v121, v72, v73, v74
  v_max3_f32 v122, v75, v76, v77
  v_min3_f32 v123, v75, v76, v77
  v_max3_f32 v120, v120, v78, v79
  v_min3_f32 v121, v121, v78, v79
  v_max3_f32 v122, v122, v80, v81
  v_min3_f32 v123, v123, v80, v81
  v_max3_f32 v120, v120, v82, v83
  v_min3_f32 v121, v121, v82, v83
  v_max3_f32 v122, v122, v84, v85
  v_min3_f32 v123, v123, v84, v85
  v_max3_f32 v120, v120, v86, v87
  v_min3_f32 v121, v121, v86, v87
  v_max_f32 v120, v120, v122
  v_min_f32 v121, v121, v123
  v_mov_b32 v122, v120
  v_mov_b32 v123, v121
  s_nop 0
  v_permlane32_swap_b32 v120, v122
  v_permlane32_swap_b32 v121, v123
  v_max_f32 v120, v120, v122
  v_min_f32 v121, v121, v123
  v_mul_f32 v124, s47, v120
  v_mul_f32 v126, s47, v121
  v_pk_fma_f32 v[88:89], v[72:73], s[46:47], v[124:125] op_sel:[0,1,0] op_sel_hi:[1,1,0] neg_lo:[0,0,1] neg_hi:[0,0,1]
  v_pk_fma_f32 v[104:105], v[72:73], s[46:47], v[126:127] op_sel:[0,1,0] op_sel_hi:[1,1,0] neg_lo:[1,0,0] neg_hi:[1,0,0]
  v_pk_fma_f32 v[90:91], v[74:75], s[46:47], v[124:125] op_sel:[0,1,0] op_sel_hi:[1,1,0] neg_lo:[0,0,1] neg_hi:[0,0,1]
  v_pk_fma_f32 v[106:107], v[74:75], s[46:47], v[126:127] op_sel:[0,1,0] op_sel_hi:[1,1,0] neg_lo:[1,0,0] neg_hi:[1,0,0]
  v_pk_fma_f32 v[92:93], v[76:77], s[46:47], v[124:125] op_sel:[0,1,0] op_sel_hi:[1,1,0] neg_lo:[0,0,1] neg_hi:[0,0,1]
  v_pk_fma_f32 v[108:109], v[76:77], s[46:47], v[126:127] op_sel:[0,1,0] op_sel_hi:[1,1,0] neg_lo:[1,0,0] neg_hi:[1,0,0]
  v_pk_fma_f32 v[94:95], v[78:79], s[46:47], v[124:125] op_sel:[0,1,0] op_sel_hi:[1,1,0] neg_lo:[0,0,1] neg_hi:[0,0,1]
  v_pk_fma_f32 v[110:111], v[78:79], s[46:47], v[126:127] op_sel:[0,1,0] op_sel_hi:[1,1,0] neg_lo:[1,0,0] neg_hi:[1,0,0]
  v_pk_fma_f32 v[96:97], v[80:81], s[46:47], v[124:125] op_sel:[0,1,0] op_sel_hi:[1,1,0] neg_lo:[0,0,1] neg_hi:[0,0,1]
  v_pk_fma_f32 v[112:113], v[80:81], s[46:47], v[126:127] op_sel:[0,1,0] op_sel_hi:[1,1,0] neg_lo:[1,0,0] neg_hi:[1,0,0]
  v_pk_fma_f32 v[98:99], v[82:83], s[46:47], v[124:125] op_sel:[0,1,0] op_sel_hi:[1,1,0] neg_lo:[0,0,1] neg_hi:[0,0,1]
  v_pk_fma_f32 v[114:115], v[82:83], s[46:47], v[126:127] op_sel:[0,1,0] op_sel_hi:[1,1,0] neg_lo:[1,0,0] neg_hi:[1,0,0]
  v_pk_fma_f32 v[100:101], v[84:85], s[46:47], v[124:125] op_sel:[0,1,0] op_sel_hi:[1,1,0] neg_lo:[0,0,1] neg_hi:[0,0,1]
  v_pk_fma_f32 v[116:117], v[84:85], s[46:47], v[126:127] op_sel:[0,1,0] op_sel_hi:[1,1,0] neg_lo:[1,0,0] neg_hi:[1,0,0]
  v_pk_fma_f32 v[102:103], v[86:87], s[46:47], v[124:125] op_sel:[0,1,0] op_sel_hi:[1,1,0] neg_lo:[0,0,1] neg_hi:[0,0,1]
  v_pk_fma_f32 v[118:119], v[86:87], s[46:47], v[126:127] op_sel:[0,1,0] op_sel_hi:[1,1,0] neg_lo:[1,0,0] neg_hi:[1,0,0]
  v_exp_f32 v88, v88
  v_exp_f32 v104, v104
  v_exp_f32 v89, v89
  v_exp_f32 v105, v105
  v_exp_f32 v90, v90
  v_exp_f32 v106, v106
  v_exp_f32 v91, v91
  v_exp_f32 v107, v107
  v_exp_f32 v92, v92
  v_exp_f32 v108, v108
  v_exp_f32 v93, v93
  v_exp_f32 v109, v109
  v_exp_f32 v94, v94
  v_exp_f32 v110, v110
  v_exp_f32 v95, v95
  v_exp_f32 v111, v111
  v_exp_f32 v96, v96
  v_exp_f32 v112, v112
  v_exp_f32 v97, v97
  v_exp_f32 v113, v113
  v_exp_f32 v98, v98
  v_exp_f32 v114, v114
  v_exp_f32 v99, v99
  v_exp_f32 v115, v115
  v_exp_f32 v100, v100
  v_exp_f32 v116, v116
  v_exp_f32 v101, v101
  v_exp_f32 v117, v117
  v_exp_f32 v102, v102
  v_exp_f32 v118, v118
  v_exp_f32 v103, v103
  v_exp_f32 v119, v119
  v_pk_add_f32 v[72:73], v[88:89], v[90:91]
  v_pk_add_f32 v[74:75], v[92:93], v[94:95]
  v_pk_add_f32 v[76:77], v[96:97], v[98:99]
  v_pk_add_f32 v[78:79], v[100:101], v[102:103]
  v_pk_add_f32 v[80:81], v[104:105], v[106:107]
  v_pk_add_f32 v[82:83], v[108:109], v[110:111]
  v_pk_add_f32 v[84:85], v[112:113], v[114:115]
  v_pk_add_f32 v[86:87], v[116:117], v[118:119]
  v_pk_add_f32 v[72:73], v[72:73], v[74:75]
  v_add_f32 v78, v78, v79
  v_pk_add_f32 v[80:81], v[80:81], v[82:83]
  v_add_f32 v86, v86, v87
  v_pk_add_f32 v[72:73], v[72:73], v[76:77]
  v_pk_add_f32 v[80:81], v[80:81], v[84:85]
  v_add_f32 v72, v72, v73
  v_add_f32 v80, v80, v81
  v_fmac_f32 v72, v9, v78
  v_fmac_f32 v80, v9, v86
  v_mov_b32 v73, v72
  v_mov_b32 v81, v80
  s_nop 0
  v_permlane32_swap_b32 v72, v73
  v_permlane32_swap_b32 v80, v81
  v_add_f32 v72, v72, v73
  v_add_f32 v80, v80, v81
  v_rcp_f32 v72, v72
  v_rcp_f32 v80, v80
  v_mul_f32 v74, v9, v72
  v_mul_f32 v82, v9, v80
  v_pk_mul_f32 v[88:89], v[88:89], v[72:73] op_sel:[0,0] op_sel_hi:[1,0]
  v_pk_mul_f32 v[90:91], v[90:91], v[72:73] op_sel:[0,0] op_sel_hi:[1,0]
  v_pk_mul_f32 v[92:93], v[92:93], v[72:73] op_sel:[0,0] op_sel_hi:[1,0]
  v_pk_mul_f32 v[94:95], v[94:95], v[72:73] op_sel:[0,0] op_sel_hi:[1,0]
  v_pk_mul_f32 v[96:97], v[96:97], v[72:73] op_sel:[0,0] op_sel_hi:[1,0]
  v_pk_mul_f32 v[98:99], v[98:99], v[72:73] op_sel:[0,0] op_sel_hi:[1,0]
  v_pk_mul_f32 v[100:101], v[100:101], v[74:75] op_sel:[0,0] op_sel_hi:[1,0]
  v_pk_mul_f32 v[102:103], v[102:103], v[74:75] op_sel:[0,0] op_sel_hi:[1,0]
  v_cvt_pk_bf16_f32 v32, v88, v89
  v_cvt_pk_bf16_f32 v33, v90, v91
  v_cvt_pk_bf16_f32 v34, v92, v93
  v_cvt_pk_bf16_f32 v35, v94, v95
  v_cvt_pk_bf16_f32 v36, v96, v97
  v_cvt_pk_bf16_f32 v37, v98, v99
  v_cvt_pk_bf16_f32 v38, v100, v101
  v_cvt_pk_bf16_f32 v39, v102, v103
  v_pk_mul_f32 v[104:105], v[104:105], v[80:81] op_sel:[0,0] op_sel_hi:[1,0]
  v_pk_mul_f32 v[106:107], v[106:107], v[80:81] op_sel:[0,0] op_sel_hi:[1,0]
  v_pk_mul_f32 v[108:109], v[108:109], v[80:81] op_sel:[0,0] op_sel_hi:[1,0]
  v_pk_mul_f32 v[110:111], v[110:111], v[80:81] op_sel:[0,0] op_sel_hi:[1,0]
  v_pk_mul_f32 v[112:113], v[112:113], v[80:81] op_sel:[0,0] op_sel_hi:[1,0]
  v_pk_mul_f32 v[114:115], v[114:115], v[80:81] op_sel:[0,0] op_sel_hi:[1,0]
  v_pk_mul_f32 v[116:117], v[116:117], v[82:83] op_sel:[0,0] op_sel_hi:[1,0]
  v_pk_mul_f32 v[118:119], v[118:119], v[82:83] op_sel:[0,0] op_sel_hi:[1,0]
  v_cvt_pk_bf16_f32 v40, v104, v105
  v_cvt_pk_bf16_f32 v41, v106, v107
  v_cvt_pk_bf16_f32 v42, v108, v109
  v_cvt_pk_bf16_f32 v43, v110, v111
  v_cvt_pk_bf16_f32 v44, v112, v113
  v_cvt_pk_bf16_f32 v45, v114, v115
  v_cvt_pk_bf16_f32 v46, v116, v117
  v_cvt_pk_bf16_f32 v47, v118, v119
  v_mfma_f32_32x32x16_bf16 v[64:79], v[32:35], v[248:251], 0
  v_mfma_f32_32x32x16_bf16 v[64:79], v[36:39], v[252:255], v[64:79]
  v_mfma_f32_32x32x16_bf16 v[80:95], v[40:43], v[248:251], 0
  v_mfma_f32_32x32x16_bf16 v[80:95], v[44:47], v[252:255], v[80:95]
  s_nop 9
  v_cvt_pk_bf16_f32 v96, v64, v65
  v_cvt_pk_bf16_f32 v97, v66, v67
  v_cvt_pk_bf16_f32 v98, v68, v69
  v_cvt_pk_bf16_f32 v99, v70, v71
  v_cvt_pk_bf16_f32 v100, v72, v73
  v_cvt_pk_bf16_f32 v101, v74, v75
  v_cvt_pk_bf16_f32 v102, v76, v77
  v_cvt_pk_bf16_f32 v103, v78, v79
  v_cvt_pk_bf16_f32 v104, v80, v81
  v_cvt_pk_bf16_f32 v105, v82, v83
  v_cvt_pk_bf16_f32 v106, v84, v85
  v_cvt_pk_bf16_f32 v107, v86, v87
  v_cvt_pk_bf16_f32 v108, v88, v89
  v_cvt_pk_bf16_f32 v109, v90, v91
  v_cvt_pk_bf16_f32 v110, v92, v93
  v_cvt_pk_bf16_f32 v111, v94, v95
  v_mfma_f32_32x32x16_bf16 v[64:79], v[96:99], v[12:15], 0
  v_mfma_f32_32x32x16_bf16 v[64:79], v[100:103], v[16:19], v[64:79]
  v_mfma_f32_32x32x16_bf16 v[80:95], v[104:107], v[12:15], 0
  v_mfma_f32_32x32x16_bf16 v[80:95], v[108:111], v[16:19], v[80:95]
  v_lshlrev_b32 v2, 4, v1
  s_lshl_b32 s48, s6, 13
  s_add_u32 s48, s48, 0
  v_add_u32 v10, s48, v2
  s_lshl_b32 s48, s6, 10
  v_add_u32 v26, s48, v2
  v_add_u32 v11, 0, v26
  s_barrier
  s_nop 1
  ds_write_b128 v10, v[64:67] offset:0
  ds_write_b128 v10, v[68:71] offset:1024
  ds_write_b128 v10, v[72:75] offset:2048
  ds_write_b128 v10, v[76:79] offset:3072
  ds_write_b128 v10, v[80:83] offset:4096
  ds_write_b128 v10, v[84:87] offset:5120
  ds_write_b128 v10, v[88:91] offset:6144
  ds_write_b128 v10, v[92:95] offset:7168
  s_waitcnt lgkmcnt(0)
  s_barrier
  ds_read_b128 v[64:67], v11 offset:0
  ds_read_b128 v[68:71], v11 offset:8192
  ds_read_b128 v[72:75], v11 offset:16384
  ds_read_b128 v[76:79], v11 offset:24576
  ds_read_b128 v[80:83], v11 offset:32768
  ds_read_b128 v[84:87], v11 offset:40960
  ds_read_b128 v[88:91], v11 offset:49152
  ds_read_b128 v[92:95], v11 offset:57344
  s_waitcnt lgkmcnt(0)
  v_pk_add_f32 v[64:65], v[64:65], v[68:69]
  v_pk_add_f32 v[66:67], v[66:67], v[70:71]
  v_pk_add_f32 v[72:73], v[72:73], v[76:77]
  v_pk_add_f32 v[74:75], v[74:75], v[78:79]
  v_pk_add_f32 v[80:81], v[80:81], v[84:85]
  v_pk_add_f32 v[82:83], v[82:83], v[86:87]
  v_pk_add_f32 v[88:89], v[88:89], v[92:93]
  v_pk_add_f32 v[90:91], v[90:91], v[94:95]
  v_pk_add_f32 v[64:65], v[64:65], v[72:73]
  v_pk_add_f32 v[66:67], v[66:67], v[74:75]
  v_pk_add_f32 v[80:81], v[80:81], v[88:89]
  v_pk_add_f32 v[82:83], v[82:83], v[90:91]
  v_pk_add_f32 v[64:65], v[64:65], v[80:81]
  v_pk_add_f32 v[66:67], v[66:67], v[82:83]
  s_lshl_b32 s49, s7, 16
  s_lshl_b32 s48, s5, 13
  s_add_u32 s48, s48, s49
  s_add_u32 s48, s48, 4194304
  s_add_u32 s49, s49, 4194304
  buffer_store_dwordx4 v[64:67], v26, s[12:15], s48 offen sc1
  s_waitcnt vmcnt(0)
  s_barrier
  s_cmp_lg_u32 s6, 0
  s_cbranch_scc1 LA_nopub
  v_readfirstlane_b32 s96, v31
  s_nop 0
  s_cmp_lg_u32 s96, 0
  s_cbranch_scc1 LA_tok_ok
  v_mov_b32 v16, 0
  s_mov_b32 s51, 0
LA_tok:
  global_load_dword v2, v16, s[32:33] sc1
  s_waitcnt vmcnt(0)
  v_readfirstlane_b32 s96, v2
  s_nop 0
  s_cmp_lg_u32 s96, 0
  s_cbranch_scc1 LA_tok_ok
  s_sleep 4
  s_add_u32 s51, s51, 1
  s_cmp_lt_u32 s51, 0x20000
  s_cbranch_scc1 LA_tok
LA_tok_ok:
  s_lshl_b32 s51, s7, 7
  s_add_u32 s51, s51, 9502720
  s_lshl_b32 s54, s5, 2
  s_add_u32 s54, s54, s51
  v_mov_b32 v2, s96
  v_mov_b32 v27, s54
  s_mov_b64 s[56:57], exec
  s_mov_b64 exec, 1
  buffer_store_dword v2, v27, s[12:15], 0 offen sc1
  s_mov_b64 exec, s[56:57]
  v_lshlrev_b32 v27, 2, v1
  v_add_u32 v27, s51, v27
LA_nopub:
  s_cmp_ge_u32 s2, 224
  s_cbranch_scc1 LA_nowo
  v_lshrrev_b32 v10, 3, v1
  v_bfe_u32 v11, v1, 4, 1
  v_lshlrev_b32 v11, 2, v11
  v_xor_b32 v11, v11, v1
  v_and_b32 v11, 7, v11
  v_mul_u32_u24 v10, 896, v10
  v_lshl_add_u32 v10, v11, 4, v10
  s_lshl_b32 s86, s84, 7
  s_mul_i32 s87, s6, 7168
  s_add_u32 s86, s86, s87
  s_lshl_b32 s87, s6, 10
  s_add_u32 m0, s87, 0
  s_add_u32 s95, s86, 0
  buffer_load_dwordx4 v10, s[80:83], s95 offen lds
  s_add_u32 m0, s87, 8192
  s_add_u32 s95, s86, 57344
  buffer_load_dwordx4 v10, s[80:83], s95 offen lds
  s_add_u32 m0, s87, 16384
  s_add_u32 s95, s86, 114688
  buffer_load_dwordx4 v10, s[80:83], s95 offen lds
  s_add_u32 m0, s87, 24576
  s_add_u32 s95, s86, 172032
  buffer_load_dwordx4 v10, s[80:83], s95 offen lds
  s_add_u32 m0, s87, 32768
  s_add_u32 s95, s86, 229376
  buffer_load_dwordx4 v10, s[80:83], s95 offen lds
  s_add_u32 m0, s87, 40960
  s_add_u32 s95, s86, 286720
  buffer_load_dwordx4 v10, s[80:83], s95 offen lds
  s_add_u32 m0, s87, 49152
  s_add_u32 s95, s86, 344064
  buffer_load_dwordx4 v10, s[80:83], s95 offen lds
LA_nowo:
  v_cvt_pk_bf16_f32 v64, v192, v193
  v_cvt_pk_bf16_f32 v65, v194, v195
  v_cvt_pk_bf16_f32 v66, v196, v197
  v_cvt_pk_bf16_f32 v67, v198, v199
  v_cvt_pk_bf16_f32 v68, v200, v201
  v_cvt_pk_bf16_f32 v69, v202, v203
  v_cvt_pk_bf16_f32 v70, v204, v205
  v_cvt_pk_bf16_f32 v71, v206, v207
  v_mfma_f32_32x32x16_bf16 v[72:87], v[240:243], v[64:67], 0
  s_nop 0
  v_mfma_f32_32x32x16_bf16 v[72:87], v[244:247], v[68:71], v[72:87]
  v_and_b32 v10, 0xffff0000, v70
  v_mul_f32 v10, s47, v10
  v_sub_f32 v10, 0, v10
  v_exp_f32 v10, v10
  s_nop 0
  v_add_f32 v10, 1.0, v10
  v_rcp_f32 v10, v10
  s_nop 0
  v_cvt_pk_bf16_f32 v10, v10, v10
  v_lshlrev_b32 v10, 16, v10
  v_lshlrev_b32 v11, 2, v5
  s_cmp_lg_u32 s7, 0
  s_cbranch_scc1 LA_nog
  s_mov_b64 s[56:57], exec
  s_mov_b64 exec, s[52:53]
  s_mov_b32 s48, 8388608
  buffer_store_dword v10, v11, s[12:15], s48 offen sc1
  s_mov_b64 exec, s[56:57]
LA_nog:
  v_cvt_pk_bf16_f32 v88, v72, v73
  v_cvt_pk_bf16_f32 v89, v74, v75
  v_cvt_pk_bf16_f32 v90, v76, v77
  v_cvt_pk_bf16_f32 v91, v78, v79
  v_cvt_pk_bf16_f32 v92, v80, v81
  v_cvt_pk_bf16_f32 v93, v82, v83
  v_cvt_pk_bf16_f32 v94, v84, v85
  v_cvt_pk_bf16_f32 v95, v86, v87
  v_lshlrev_b32 v72, 16, v88
  v_and_b32 v73, 0xffff0000, v88
  v_lshlrev_b32 v74, 16, v89
  v_and_b32 v75, 0xffff0000, v89
  v_lshlrev_b32 v76, 16, v90
  v_and_b32 v77, 0xffff0000, v90
  v_lshlrev_b32 v78, 16, v91
  v_and_b32 v79, 0xffff0000, v91
  v_lshlrev_b32 v80, 16, v92
  v_and_b32 v81, 0xffff0000, v92
  v_lshlrev_b32 v82, 16, v93
  v_and_b32 v83, 0xffff0000, v93
  v_lshlrev_b32 v84, 16, v94
  v_and_b32 v85, 0xffff0000, v94
  v_lshlrev_b32 v86, 16, v95
  v_and_b32 v87, 0xffff0000, v95
  v_max3_f32 v120, v72, v73, v74
  v_min3_f32 v121, v72, v73, v74
  v_max3_f32 v122, v75, v76, v77
  v_min3_f32 v123, v75, v76, v77
  v_max3_f32 v120, v120, v78, v79
  v_min3_f32 v121, v121, v78, v79
  v_max3_f32 v122, v122, v80, v81
  v_min3_f32 v123, v123, v80, v81
  v_max3_f32 v120, v120, v82, v83
  v_min3_f32 v121, v121, v82, v83
  v_max3_f32 v122, v122, v84, v85
  v_min3_f32 v123, v123, v84, v85
  v_max3_f32 v120, v120, v86, v87
  v_min3_f32 v121, v121, v86, v87
  v_max_f32 v120, v120, v122
  v_min_f32 v121, v121, v123
  v_mov_b32 v122, v120
  v_mov_b32 v123, v121
  s_nop 0
  v_permlane32_swap_b32 v120, v122
  v_permlane32_swap_b32 v121, v123
  v_max_f32 v120, v120, v122
  v_min_f32 v121, v121, v123
  v_mul_f32 v124, s47, v120
  v_mul_f32 v126, s47, v121
  v_pk_fma_f32 v[88:89], v[72:73], s[46:47], v[124:125] op_sel:[0,1,0] op_sel_hi:[1,1,0] neg_lo:[0,0,1] neg_hi:[0,0,1]
  v_pk_fma_f32 v[104:105], v[72:73], s[46:47], v[126:127] op_sel:[0,1,0] op_sel_hi:[1,1,0] neg_lo:[1,0,0] neg_hi:[1,0,0]
  v_pk_fma_f32 v[90:91], v[74:75], s[46:47], v[124:125] op_sel:[0,1,0] op_sel_hi:[1,1,0] neg_lo:[0,0,1] neg_hi:[0,0,1]
  v_pk_fma_f32 v[106:107], v[74:75], s[46:47], v[126:127] op_sel:[0,1,0] op_sel_hi:[1,1,0] neg_lo:[1,0,0] neg_hi:[1,0,0]
  v_pk_fma_f32 v[92:93], v[76:77], s[46:47], v[124:125] op_sel:[0,1,0] op_sel_hi:[1,1,0] neg_lo:[0,0,1] neg_hi:[0,0,1]
  v_pk_fma_f32 v[108:109], v[76:77], s[46:47], v[126:127] op_sel:[0,1,0] op_sel_hi:[1,1,0] neg_lo:[1,0,0] neg_hi:[1,0,0]
  v_pk_fma_f32 v[94:95], v[78:79], s[46:47], v[124:125] op_sel:[0,1,0] op_sel_hi:[1,1,0] neg_lo:[0,0,1] neg_hi:[0,0,1]
  v_pk_fma_f32 v[110:111], v[78:79], s[46:47], v[126:127] op_sel:[0,1,0] op_sel_hi:[1,1,0] neg_lo:[1,0,0] neg_hi:[1,0,0]
  v_pk_fma_f32 v[96:97], v[80:81], s[46:47], v[124:125] op_sel:[0,1,0] op_sel_hi:[1,1,0] neg_lo:[0,0,1] neg_hi:[0,0,1]
  v_pk_fma_f32 v[112:113], v[80:81], s[46:47], v[126:127] op_sel:[0,1,0] op_sel_hi:[1,1,0] neg_lo:[1,0,0] neg_hi:[1,0,0]
  v_pk_fma_f32 v[98:99], v[82:83], s[46:47], v[124:125] op_sel:[0,1,0] op_sel_hi:[1,1,0] neg_lo:[0,0,1] neg_hi:[0,0,1]
  v_pk_fma_f32 v[114:115], v[82:83], s[46:47], v[126:127] op_sel:[0,1,0] op_sel_hi:[1,1,0] neg_lo:[1,0,0] neg_hi:[1,0,0]
  v_pk_fma_f32 v[100:101], v[84:85], s[46:47], v[124:125] op_sel:[0,1,0] op_sel_hi:[1,1,0] neg_lo:[0,0,1] neg_hi:[0,0,1]
  v_pk_fma_f32 v[116:117], v[84:85], s[46:47], v[126:127] op_sel:[0,1,0] op_sel_hi:[1,1,0] neg_lo:[1,0,0] neg_hi:[1,0,0]
  v_pk_fma_f32 v[102:103], v[86:87], s[46:47], v[124:125] op_sel:[0,1,0] op_sel_hi:[1,1,0] neg_lo:[0,0,1] neg_hi:[0,0,1]
  v_pk_fma_f32 v[118:119], v[86:87], s[46:47], v[126:127] op_sel:[0,1,0] op_sel_hi:[1,1,0] neg_lo:[1,0,0] neg_hi:[1,0,0]
  v_exp_f32 v88, v88
  v_exp_f32 v104, v104
  v_exp_f32 v89, v89
  v_exp_f32 v105, v105
  v_exp_f32 v90, v90
  v_exp_f32 v106, v106
  v_exp_f32 v91, v91
  v_exp_f32 v107, v107
  v_exp_f32 v92, v92
  v_exp_f32 v108, v108
  v_exp_f32 v93, v93
  v_exp_f32 v109, v109
  v_exp_f32 v94, v94
  v_exp_f32 v110, v110
  v_exp_f32 v95, v95
  v_exp_f32 v111, v111
  v_exp_f32 v96, v96
  v_exp_f32 v112, v112
  v_exp_f32 v97, v97
  v_exp_f32 v113, v113
  v_exp_f32 v98, v98
  v_exp_f32 v114, v114
  v_exp_f32 v99, v99
  v_exp_f32 v115, v115
  v_exp_f32 v100, v100
  v_exp_f32 v116, v116
  v_exp_f32 v101, v101
  v_exp_f32 v117, v117
  v_exp_f32 v102, v102
  v_exp_f32 v118, v118
  v_exp_f32 v103, v103
  v_exp_f32 v119, v119
  v_pk_add_f32 v[72:73], v[88:89], v[90:91]
  v_pk_add_f32 v[74:75], v[92:93], v[94:95]
  v_pk_add_f32 v[76:77], v[96:97], v[98:99]
  v_pk_add_f32 v[78:79], v[100:101], v[102:103]
  v_pk_add_f32 v[80:81], v[104:105], v[106:107]
  v_pk_add_f32 v[82:83], v[108:109], v[110:111]
  v_pk_add_f32 v[84:85], v[112:113], v[114:115]
  v_pk_add_f32 v[86:87], v[116:117], v[118:119]
  v_pk_add_f32 v[72:73], v[72:73], v[74:75]
  v_add_f32 v78, v78, v79
  v_pk_add_f32 v[80:81], v[80:81], v[82:83]
  v_add_f32 v86, v86, v87
  v_pk_add_f32 v[72:73], v[72:73], v[76:77]
  v_pk_add_f32 v[80:81], v[80:81], v[84:85]
  v_add_f32 v72, v72, v73
  v_add_f32 v80, v80, v81
  v_fmac_f32 v72, v9, v78
  v_fmac_f32 v80, v9, v86
  v_mov_b32 v73, v72
  v_mov_b32 v81, v80
  s_nop 0
  v_permlane32_swap_b32 v72, v73
  v_permlane32_swap_b32 v80, v81
  v_add_f32 v72, v72, v73
  v_add_f32 v80, v80, v81
  v_rcp_f32 v72, v72
  v_rcp_f32 v80, v80
  v_mul_f32 v74, v9, v72
  v_mul_f32 v82, v9, v80
  v_pk_mul_f32 v[88:89], v[88:89], v[72:73] op_sel:[0,0] op_sel_hi:[1,0]
  v_pk_mul_f32 v[90:91], v[90:91], v[72:73] op_sel:[0,0] op_sel_hi:[1,0]
  v_pk_mul_f32 v[92:93], v[92:93], v[72:73] op_sel:[0,0] op_sel_hi:[1,0]
  v_pk_mul_f32 v[94:95], v[94:95], v[72:73] op_sel:[0,0] op_sel_hi:[1,0]
  v_pk_mul_f32 v[96:97], v[96:97], v[72:73] op_sel:[0,0] op_sel_hi:[1,0]
  v_pk_mul_f32 v[98:99], v[98:99], v[72:73] op_sel:[0,0] op_sel_hi:[1,0]
  v_pk_mul_f32 v[100:101], v[100:101], v[74:75] op_sel:[0,0] op_sel_hi:[1,0]
  v_pk_mul_f32 v[102:103], v[102:103], v[74:75] op_sel:[0,0] op_sel_hi:[1,0]
  v_cvt_pk_bf16_f32 v32, v88, v89
  v_cvt_pk_bf16_f32 v33, v90, v91
  v_cvt_pk_bf16_f32 v34, v92, v93
  v_cvt_pk_bf16_f32 v35, v94, v95
  v_cvt_pk_bf16_f32 v36, v96, v97
  v_cvt_pk_bf16_f32 v37, v98, v99
  v_cvt_pk_bf16_f32 v38, v100, v101
  v_cvt_pk_bf16_f32 v39, v102, v103
  v_pk_mul_f32 v[104:105], v[104:105], v[80:81] op_sel:[0,0] op_sel_hi:[1,0]
  v_pk_mul_f32 v[106:107], v[106:107], v[80:81] op_sel:[0,0] op_sel_hi:[1,0]
  v_pk_mul_f32 v[108:109], v[108:109], v[80:81] op_sel:[0,0] op_sel_hi:[1,0]
  v_pk_mul_f32 v[110:111], v[110:111], v[80:81] op_sel:[0,0] op_sel_hi:[1,0]
  v_pk_mul_f32 v[112:113], v[112:113], v[80:81] op_sel:[0,0] op_sel_hi:[1,0]
  v_pk_mul_f32 v[114:115], v[114:115], v[80:81] op_sel:[0,0] op_sel_hi:[1,0]
  v_pk_mul_f32 v[116:117], v[116:117], v[82:83] op_sel:[0,0] op_sel_hi:[1,0]
  v_pk_mul_f32 v[118:119], v[118:119], v[82:83] op_sel:[0,0] op_sel_hi:[1,0]
  v_cvt_pk_bf16_f32 v40, v104, v105
  v_cvt_pk_bf16_f32 v41, v106, v107
  v_cvt_pk_bf16_f32 v42, v108, v109
  v_cvt_pk_bf16_f32 v43, v110, v111
  v_cvt_pk_bf16_f32 v44, v112, v113
  v_cvt_pk_bf16_f32 v45, v114, v115
  v_cvt_pk_bf16_f32 v46, v116, v117
  v_cvt_pk_bf16_f32 v47, v118, v119
  s_cmp_lg_u32 s6, 0
  s_cbranch_scc1 LA_nopoll
  s_mov_b32 s51, 0
  s_mov_b64 s[56:57], exec
  s_mov_b64 exec, 0xff
LA_poll:
  buffer_load_dword v18, v27, s[12:15], 0 offen sc1
  s_waitcnt vmcnt(0)
  v_cmp_ne_u32 vcc, s96, v18
  s_cbranch_vccz LA_poll_ok
  s_sleep 2
  s_add_u32 s51, s51, 1
  s_cmp_lt_u32 s51, 0x20000
  s_cbranch_scc1 LA_poll
LA_poll_ok:
  s_mov_b64 exec, s[56:57]
LA_nopoll:
  s_barrier
  s_add_u32 s48, s49, 0
  buffer_load_dwordx4 v[64:67], v26, s[12:15], s48 offen sc1
  s_add_u32 s48, s49, 8192
  buffer_load_dwordx4 v[68:71], v26, s[12:15], s48 offen sc1
  s_add_u32 s48, s49, 16384
  buffer_load_dwordx4 v[72:75], v26, s[12:15], s48 offen sc1
  s_add_u32 s48, s49, 24576
  buffer_load_dwordx4 v[76:79], v26, s[12:15], s48 offen sc1
  s_add_u32 s48, s49, 32768
  buffer_load_dwordx4 v[80:83], v26, s[12:15], s48 offen sc1
  s_add_u32 s48, s49, 40960
  buffer_load_dwordx4 v[84:87], v26, s[12:15], s48 offen sc1
  s_add_u32 s48, s49, 49152
  buffer_load_dwordx4 v[88:91], v26, s[12:15], s48 offen sc1
  s_add_u32 s48, s49, 57344
  buffer_load_dwordx4 v[92:95], v26, s[12:15], s48 offen sc1
  s_waitcnt vmcnt(0)
  v_pk_add_f32 v[64:65], v[64:65], v[68:69]
  v_pk_add_f32 v[66:67], v[66:67], v[70:71]
  v_pk_add_f32 v[72:73], v[72:73], v[76:77]
  v_pk_add_f32 v[74:75], v[74:75], v[78:79]
  v_pk_add_f32 v[80:81], v[80:81], v[84:85]
  v_pk_add_f32 v[82:83], v[82:83], v[86:87]
  v_pk_add_f32 v[88:89], v[88:89], v[92:93]
  v_pk_add_f32 v[90:91], v[90:91], v[94:95]
  v_pk_add_f32 v[64:65], v[64:65], v[72:73]
  v_pk_add_f32 v[66:67], v[66:67], v[74:75]
  v_pk_add_f32 v[80:81], v[80:81], v[88:89]
  v_pk_add_f32 v[82:83], v[82:83], v[90:91]
  v_pk_add_f32 v[64:65], v[64:65], v[80:81]
  v_pk_add_f32 v[66:67], v[66:67], v[82:83]
  v_cvt_pk_bf16_f32 v72, v64, v65
  v_cvt_pk_bf16_f32 v73, v66, v67
  v_lshlrev_b32 v2, 4, v1
  s_lshr_b32 s48, s6, 1
  s_lshl_b32 s48, s48, 10
  s_and_b32 s51, s6, 1
  s_lshl_b32 s51, s51, 3
  s_add_u32 s48, s48, s51
  s_add_u32 s48, s48, 151552
  v_add_u32 v10, s48, v2
  ds_write_b64 v10, v[72:73]
  v_add_u32 v2, 151552, v2
  s_waitcnt lgkmcnt(0)
  s_barrier
  ds_read_b128 v[80:83], v2 offset:0
  ds_read_b128 v[84:87], v2 offset:1024
  ds_read_b128 v[88:91], v2 offset:2048
  ds_read_b128 v[92:95], v2 offset:3072
  s_waitcnt lgkmcnt(0)
  v_mfma_f32_32x32x16_bf16 v[96:111], v[80:83], v[32:35], 0
  v_mfma_f32_32x32x16_bf16 v[96:111], v[84:87], v[36:39], v[96:111]
  v_mfma_f32_32x32x16_bf16 v[96:111], v[88:91], v[40:43], v[96:111]
  v_mfma_f32_32x32x16_bf16 v[96:111], v[92:95], v[44:47], v[96:111]
  s_nop 11
  v_cvt_pk_bf16_f32 v112, v96, v97
  v_cvt_pk_bf16_f32 v113, v98, v99
  v_cvt_pk_bf16_f32 v114, v100, v101
  v_cvt_pk_bf16_f32 v115, v102, v103
  v_cvt_pk_bf16_f32 v116, v104, v105
  v_cvt_pk_bf16_f32 v117, v106, v107
  v_cvt_pk_bf16_f32 v118, v108, v109
  v_cvt_pk_bf16_f32 v119, v110, v111
  v_lshlrev_b32 v10, 16, v118
  v_mov_b32 v11, v10
  s_nop 1
  v_permlane32_swap_b32 v11, v10
  v_add_f32 v10, 0x358637bd, v10
  v_cvt_pk_bf16_f32 v10, v10, v10
  v_lshlrev_b32 v10, 16, v10
  v_rcp_f32 v10, v10
  v_lshlrev_b32 v96, 16, v112
  v_and_b32 v97, 0xffff0000, v112
  v_lshlrev_b32 v98, 16, v113
  v_and_b32 v99, 0xffff0000, v113
  v_lshlrev_b32 v100, 16, v114
  v_and_b32 v101, 0xffff0000, v114
  v_lshlrev_b32 v102, 16, v115
  v_and_b32 v103, 0xffff0000, v115
  v_lshlrev_b32 v104, 16, v116
  v_and_b32 v105, 0xffff0000, v116
  v_lshlrev_b32 v106, 16, v117
  v_and_b32 v107, 0xffff0000, v117
  v_lshlrev_b32 v108, 16, v118
  v_and_b32 v109, 0xffff0000, v118
  v_lshlrev_b32 v110, 16, v119
  v_and_b32 v111, 0xffff0000, v119
  v_pk_mul_f32 v[96:97], v[96:97], v[10:11] op_sel:[0,0] op_sel_hi:[1,0]
  v_pk_mul_f32 v[98:99], v[98:99], v[10:11] op_sel:[0,0] op_sel_hi:[1,0]
  v_pk_mul_f32 v[100:101], v[100:101], v[10:11] op_sel:[0,0] op_sel_hi:[1,0]
  v_pk_mul_f32 v[102:103], v[102:103], v[10:11] op_sel:[0,0] op_sel_hi:[1,0]
  v_pk_mul_f32 v[104:105], v[104:105], v[10:11] op_sel:[0,0] op_sel_hi:[1,0]
  v_pk_mul_f32 v[106:107], v[106:107], v[10:11] op_sel:[0,0] op_sel_hi:[1,0]
  v_pk_mul_f32 v[108:109], v[108:109], v[10:11] op_sel:[0,0] op_sel_hi:[1,0]
  v_pk_mul_f32 v[110:111], v[110:111], v[10:11] op_sel:[0,0] op_sel_hi:[1,0]
  v_cvt_pk_bf16_f32 v112, v96, v97
  v_cvt_pk_bf16_f32 v113, v98, v99
  v_cvt_pk_bf16_f32 v114, v100, v101
  v_cvt_pk_bf16_f32 v115, v102, v103
  v_cvt_pk_bf16_f32 v116, v104, v105
  v_cvt_pk_bf16_f32 v117, v106, v107
  v_cvt_pk_bf16_f32 v118, v108, v109
  v_cvt_pk_bf16_f32 v119, v110, v111
  v_cndmask_b32 v118, v118, 0, s[52:53]
  v_cndmask_b32 v119, v119, 0, s[52:53]
  v_lshlrev_b32 v2, 6, v3
  v_lshl_add_u32 v2, v4, 3, v2
  s_lshl_b32 s48, s6, 11
  s_add_u32 s48, s48, 122880
  v_add_u32 v2, s48, v2
  v_lshlrev_b32 v11, 4, v1
  v_add_u32 v10, s48, v11
  ds_write_b64 v2, v[112:113] offset:0
  ds_write_b64 v2, v[114:115] offset:16
  ds_write_b64 v2, v[116:117] offset:32
  ds_write_b64 v2, v[118:119] offset:48
  s_lshl_b32 s48, s7, 17
  s_lshl_b32 s51, s43, 6
  s_add_u32 s48, s48, s51
  s_add_u32 s48, s48, 6291456
  s_waitcnt lgkmcnt(0)
  ds_read_b128 v[96:99], v10
  ds_read_b128 v[100:103], v10 offset:1024
  s_waitcnt lgkmcnt(1)
  buffer_store_dwordx4 v[96:99], v11, s[12:15], s48 offen sc1
  s_waitcnt lgkmcnt(0)
  buffer_store_dwordx4 v[100:103], v11, s[12:15], s48 offen offset:1024 sc1
  s_waitcnt vmcnt(0)
  s_barrier
  s_cmp_lg_u32 s6, 0
  s_cbranch_scc1 LA_nopub2
  v_lshlrev_b32 v27, 10, v1
  s_lshl_b32 s51, s5, 7
  s_lshl_b32 s54, s7, 2
  s_add_u32 s51, s51, s54
  s_add_u32 s51, s51, 9437184
  v_mov_b32 v2, s96
  s_mov_b64 s[56:57], exec
  s_mov_b64 exec, 0xfffffff
  buffer_store_dword v2, v27, s[12:15], s51 offen sc1
  s_mov_b64 exec, s[56:57]
LA_nopub2:
  s_cmp_ge_u32 s2, 224
  s_cbranch_scc1 LFA_exit
  s_load_dwordx2 s[36:37], s[0:1], 0
  s_load_dwordx2 s[40:41], s[0:1], 96
  s_load_dwordx2 s[38:39], s[0:1], 112
  v_and_b32 v1, 63, v0
  v_and_b32 v3, 31, v1
  v_lshrrev_b32 v4, 5, v1
  s_and_b32 s43, s6, 1
  s_bfe_u32 s44, s6, 0x10001
  s_lshr_b32 s42, s6, 2
  s_lshl_b32 s45, s85, 6
  s_lshl_b32 s46, s43, 5
  s_add_u32 s46, s45, s46
  v_add_u32 v5, s46, v3
  v_mul_u32_u24 v6, 896, v5
  v_lshrrev_b32 v8, 3, v1
  v_and_b32 v9, 7, v1
  v_lshrrev_b32 v10, 4, v1
  v_xor_b32 v10, v10, v1
  v_and_b32 v10, 3, v10
  v_lshrrev_b32 v11, 2, v1
  v_lshlrev_b32 v11, 6, v11
  v_lshl_add_u32 v11, v10, 4, v11
  v_bfe_u32 v10, v8, 1, 1
  v_lshlrev_b32 v10, 2, v10
  v_xor_b32 v10, v10, v9
  v_lshlrev_b32 v12, 12, v8
  v_lshl_add_u32 v12, v10, 4, v12
  s_waitcnt lgkmcnt(0)
  s_mov_b32 s8, s36
  s_mov_b32 s9, s37
  s_mov_b32 s10, 1835008
  s_mov_b32 s11, 0x00020000
  s_mov_b32 s20, s38
  s_mov_b32 s21, s39
  s_mov_b32 s22, 1835008
  s_mov_b32 s23, 0x00020000
  s_lshl_b32 s49, s84, 7
  s_lshl_b32 s51, s44, 6
  s_add_u32 s49, s49, s51
  s_lshl_b32 s51, s42, 5
  s_add_u32 s49, s49, s51
  v_lshl_add_u32 v13, v4, 3, v6
  v_lshlrev_b32 v14, 3, v4
  v_add_u32 v14, s49, v14
  v_lshlrev_b32 v15, 2, v5
  buffer_load_dwordx2 v[144:145], v13, s[8:11], s49 offen offset:0
  buffer_load_dwordx2 v[146:147], v13, s[8:11], s49 offen offset:16
  global_load_dwordx2 v[148:149], v14, s[40:41] offset:0
  global_load_dwordx2 v[150:151], v14, s[40:41] offset:16
  s_cmp_lg_u32 s6, 0
  s_cbranch_scc1 LFA_nopoll
  s_lshl_b32 s47, s2, 7
  s_add_u32 s47, s47, 9437184
  v_lshlrev_b32 v16, 2, v1
  v_add_u32 v16, s47, v16
  s_mov_b32 s51, 0
  s_mov_b64 s[56:57], exec
  s_mov_b64 exec, 0xffffffff
LFA_poll:
  buffer_load_dword v18, v16, s[12:15], 0 offen sc1
  s_waitcnt vmcnt(0)
  v_cmp_ne_u32 vcc, s96, v18
  s_cbranch_vccz LFA_poll_ok
  s_sleep 4
  s_add_u32 s51, s51, 1
  s_cmp_lt_u32 s51, 0x20000
  s_cbranch_scc1 LFA_poll
LFA_poll_ok:
  s_mov_b64 exec, s[56:57]
LFA_nopoll:
  s_barrier
  s_lshl_b32 s47, s6, 18
  s_lshl_b32 s51, s45, 6
  s_add_u32 s47, s47, s51
  s_add_u32 s47, s47, 6291456
  s_lshl_b32 s48, s6, 13
  s_add_u32 m0, s48, 57344
  s_add_u32 s51, s47, 0
  buffer_load_dwordx4 v11, s[12:15], s51 offen sc1 lds
  s_add_u32 m0, s48, 58368
  s_add_u32 s51, s47, 1024
  buffer_load_dwordx4 v11, s[12:15], s51 offen sc1 lds
  s_add_u32 m0, s48, 59392
  s_add_u32 s51, s47, 2048
  buffer_load_dwordx4 v11, s[12:15], s51 offen sc1 lds
  s_add_u32 m0, s48, 60416
  s_add_u32 s51, s47, 3072
  buffer_load_dwordx4 v11, s[12:15], s51 offen sc1 lds
  s_add_u32 m0, s48, 61440
  s_add_u32 s51, s47, 131072
  buffer_load_dwordx4 v11, s[12:15], s51 offen sc1 lds
  s_add_u32 m0, s48, 62464
  s_add_u32 s51, s47, 132096
  buffer_load_dwordx4 v11, s[12:15], s51 offen sc1 lds
  s_add_u32 m0, s48, 63488
  s_add_u32 s51, s47, 133120
  buffer_load_dwordx4 v11, s[12:15], s51 offen sc1 lds
  s_add_u32 m0, s48, 64512
  s_add_u32 s51, s47, 134144
  buffer_load_dwordx4 v11, s[12:15], s51 offen sc1 lds
  s_lshl_b32 s48, s6, 10
  s_lshl_b32 s47, s84, 18
  s_lshl_b32 s51, s85, 7
  s_add_u32 s47, s47, s51
  s_lshl_b32 s51, s6, 15
  s_add_u32 s47, s47, s51
  s_add_u32 s47, s47, 2097152
  s_add_u32 m0, s48, 122880
  s_mov_b32 s51, 8388608
  buffer_load_dwordx4 v12, s[12:15], s47 offen sc1 lds
  buffer_load_dword v152, v15, s[12:15], s51 offen sc1
  v_and_b32 v2, 15, v1
  v_lshrrev_b32 v8, 4, v1
  v_lshrrev_b32 v9, 1, v8
  v_lshlrev_b32 v9, 3, v9
  v_lshrrev_b32 v10, 2, v2
  v_add_u32 v9, v9, v10
  v_lshlrev_b32 v9, 7, v9
  v_and_b32 v8, 1, v8
  v_lshl_add_u32 v9, v8, 5, v9
  v_and_b32 v10, 3, v2
  v_lshl_add_u32 v9, v10, 3, v9
  v_bfe_u32 v10, v2, 3, 1
  v_xor_b32 v10, s44, v10
  v_lshl_add_u32 v9, v10, 6, v9
  s_mul_i32 s51, s42, 28672
  s_add_u32 s51, s51, 0
  v_add_u32 v9, s51, v9
  v_lshrrev_b32 v8, 4, v1
  v_lshrrev_b32 v10, 1, v8
  v_lshlrev_b32 v10, 2, v10
  v_lshrrev_b32 v12, 2, v2
  v_add_u32 v10, v10, v12
  s_lshl_b32 s51, s44, 5
  s_lshl_b32 s47, s42, 4
  s_add_u32 s51, s51, s47
  v_add_u32 v10, s51, v10
  v_lshlrev_b32 v10, 7, v10
  v_and_b32 v8, 1, v8
  v_lshl_add_u32 v10, v8, 5, v10
  v_and_b32 v12, 3, v2
  v_lshl_add_u32 v10, v12, 3, v10
  v_bfe_u32 v12, v2, 3, 1
  v_xor_b32 v12, s43, v12
  v_lshl_add_u32 v10, v12, 6, v10
  v_add_u32 v10, 122880, v10
  v_bfe_u32 v2, v3, 2, 2
  s_lshl_b32 s51, s43, 11
  s_lshl_b32 s47, s42, 15
  s_add_u32 s51, s51, s47
  s_add_u32 s51, s51, 57344
  v_lshlrev_b32 v12, 6, v3
  v_add_u32 v12, s51, v12
  v_add_u32 v20, 0, v4
  v_xor_b32 v20, v20, v2
  v_lshl_add_u32 v20, v20, 4, v12
  v_add_u32 v21, 2, v4
  v_xor_b32 v21, v21, v2
  v_lshl_add_u32 v21, v21, 4, v12
  v_lshlrev_b32 v2, 4, v1
  s_lshl_b32 s51, s6, 11
  s_add_u32 s51, s51, 131072
  v_add_u32 v22, s51, v2
  s_xor_b32 s51, s6, 4
  s_lshl_b32 s51, s51, 11
  s_add_u32 s51, s51, 131072
  v_add_u32 v23, s51, v2
  v_mov_b32 v128, 0
  v_mov_b32 v129, 0
  v_mov_b32 v130, 0
  v_mov_b32 v131, 0
  v_mov_b32 v132, 0
  v_mov_b32 v133, 0
  v_mov_b32 v134, 0
  v_mov_b32 v135, 0
  v_mov_b32 v136, 0
  v_mov_b32 v137, 0
  v_mov_b32 v138, 0
  v_mov_b32 v139, 0
  v_mov_b32 v140, 0
  v_mov_b32 v141, 0
  v_mov_b32 v142, 0
  v_mov_b32 v143, 0
  s_waitcnt vmcnt(0)
  s_barrier
  ds_read_b64_tr_b16 v[176:177], v9 offset:0
  ds_read_b64_tr_b16 v[178:179], v9 offset:512
  ds_read_b128 v[192:195], v20 offset:0
  ds_read_b64_tr_b16 v[180:181], v9 offset:2048
  ds_read_b64_tr_b16 v[182:183], v9 offset:2560
  ds_read_b128 v[196:199], v21 offset:0
  ds_read_b64_tr_b16 v[184:185], v9 offset:3584
  ds_read_b64_tr_b16 v[186:187], v9 offset:4096
  ds_read_b128 v[200:203], v20 offset:4096
  ds_read_b64_tr_b16 v[188:189], v9 offset:5632
  ds_read_b64_tr_b16 v[190:191], v9 offset:6144
  ds_read_b128 v[204:207], v21 offset:4096
  s_waitcnt lgkmcnt(0)
  v_mfma_f32_32x32x16_bf16 v[128:143], v[176:179], v[192:195], v[128:143]
  ds_read_b64_tr_b16 v[208:209], v9 offset:7168
  ds_read_b64_tr_b16 v[210:211], v9 offset:7680
  ds_read_b128 v[224:227], v20 offset:8192
  v_mfma_f32_32x32x16_bf16 v[128:143], v[180:183], v[196:199], v[128:143]
  ds_read_b64_tr_b16 v[212:213], v9 offset:9216
  ds_read_b64_tr_b16 v[214:215], v9 offset:9728
  ds_read_b128 v[228:231], v21 offset:8192
  v_mfma_f32_32x32x16_bf16 v[128:143], v[184:187], v[200:203], v[128:143]
  ds_read_b64_tr_b16 v[216:217], v9 offset:10752
  ds_read_b64_tr_b16 v[218:219], v9 offset:11264
  ds_read_b128 v[232:235], v20 offset:12288
  v_mfma_f32_32x32x16_bf16 v[128:143], v[188:191], v[204:207], v[128:143]
  ds_read_b64_tr_b16 v[220:221], v9 offset:12800
  ds_read_b64_tr_b16 v[222:223], v9 offset:13312
  ds_read_b128 v[236:239], v21 offset:12288
  s_waitcnt lgkmcnt(0)
  v_mfma_f32_32x32x16_bf16 v[128:143], v[208:211], v[224:227], v[128:143]
  ds_read_b64_tr_b16 v[176:177], v9 offset:14336
  ds_read_b64_tr_b16 v[178:179], v9 offset:14848
  ds_read_b128 v[192:195], v20 offset:16384
  v_mfma_f32_32x32x16_bf16 v[128:143], v[212:215], v[228:231], v[128:143]
  ds_read_b64_tr_b16 v[180:181], v9 offset:16384
  ds_read_b64_tr_b16 v[182:183], v9 offset:16896
  ds_read_b128 v[196:199], v21 offset:16384
  v_mfma_f32_32x32x16_bf16 v[128:143], v[216:219], v[232:235], v[128:143]
  ds_read_b64_tr_b16 v[184:185], v9 offset:17920
  ds_read_b64_tr_b16 v[186:187], v9 offset:18432
  ds_read_b128 v[200:203], v20 offset:20480
  v_mfma_f32_32x32x16_bf16 v[128:143], v[220:223], v[236:239], v[128:143]
  ds_read_b64_tr_b16 v[188:189], v9 offset:19968
  ds_read_b64_tr_b16 v[190:191], v9 offset:20480
  ds_read_b128 v[204:207], v21 offset:20480
  s_waitcnt lgkmcnt(0)
  v_mfma_f32_32x32x16_bf16 v[128:143], v[176:179], v[192:195], v[128:143]
  ds_read_b64_tr_b16 v[208:209], v9 offset:21504
  ds_read_b64_tr_b16 v[210:211], v9 offset:22016
  ds_read_b128 v[224:227], v20 offset:24576
  v_mfma_f32_32x32x16_bf16 v[128:143], v[180:183], v[196:199], v[128:143]
  ds_read_b64_tr_b16 v[212:213], v9 offset:23552
  ds_read_b64_tr_b16 v[214:215], v9 offset:24064
  ds_read_b128 v[228:231], v21 offset:24576
  v_mfma_f32_32x32x16_bf16 v[128:143], v[184:187], v[200:203], v[128:143]
  ds_read_b64_tr_b16 v[216:217], v9 offset:25088
  ds_read_b64_tr_b16 v[218:219], v9 offset:25600
  ds_read_b128 v[232:235], v20 offset:28672
  v_mfma_f32_32x32x16_bf16 v[128:143], v[188:191], v[204:207], v[128:143]
  ds_read_b64_tr_b16 v[220:221], v9 offset:27136
  ds_read_b64_tr_b16 v[222:223], v9 offset:27648
  ds_read_b128 v[236:239], v21 offset:28672
  s_waitcnt lgkmcnt(0)
  v_mfma_f32_32x32x16_bf16 v[128:143], v[208:211], v[224:227], v[128:143]
  ds_read_b64_tr_b16 v[154:155], v10 offset:0
  v_mfma_f32_32x32x16_bf16 v[128:143], v[212:215], v[228:231], v[128:143]
  v_mfma_f32_32x32x16_bf16 v[128:143], v[216:219], v[232:235], v[128:143]
  ds_read_b64_tr_b16 v[156:157], v10 offset:1024
  v_mfma_f32_32x32x16_bf16 v[128:143], v[220:223], v[236:239], v[128:143]
  s_cmp_eq_u32 s42, 0
  s_cbranch_scc1 LFA_noswap
  s_nop 9
  v_swap_b32 v128, v136
  v_swap_b32 v129, v137
  v_swap_b32 v130, v138
  v_swap_b32 v131, v139
  v_swap_b32 v132, v140
  v_swap_b32 v133, v141
  v_swap_b32 v134, v142
  v_swap_b32 v135, v143
LFA_noswap:
  s_nop 7
  s_nop 7
  ds_write_b128 v22, v[136:139]
  ds_write_b128 v22, v[140:143] offset:1024
  v_sub_f32 v153, 1.0, v152
  v_cvt_pk_bf16_f32 v153, v153, v153
  v_lshlrev_b32 v153, 16, v153
  s_waitcnt lgkmcnt(0)
  s_barrier
  ds_read_b128 v[136:139], v23
  ds_read_b128 v[140:143], v23 offset:1024
  s_waitcnt lgkmcnt(0)
  v_pk_add_f32 v[128:129], v[128:129], v[136:137]
  v_pk_add_f32 v[130:131], v[130:131], v[138:139]
  v_pk_add_f32 v[132:133], v[132:133], v[140:141]
  v_pk_add_f32 v[134:135], v[134:135], v[142:143]
  v_cvt_pk_bf16_f32 v32, v128, v129
  v_cvt_pk_bf16_f32 v33, v130, v131
  v_lshlrev_b32 v128, 16, v32
  v_and_b32 v129, 0xffff0000, v32
  v_lshlrev_b32 v130, 16, v33
  v_and_b32 v131, 0xffff0000, v33
  v_lshlrev_b32 v34, 16, v144
  v_and_b32 v35, 0xffff0000, v144
  v_lshlrev_b32 v36, 16, v145
  v_and_b32 v37, 0xffff0000, v145
  v_lshlrev_b32 v38, 16, v148
  v_and_b32 v39, 0xffff0000, v148
  v_lshlrev_b32 v40, 16, v149
  v_and_b32 v41, 0xffff0000, v149
  v_lshlrev_b32 v42, 16, v154
  v_and_b32 v43, 0xffff0000, v154
  v_lshlrev_b32 v44, 16, v155
  v_and_b32 v45, 0xffff0000, v155
  v_pk_mul_f32 v[34:35], v[34:35], v[38:39]
  v_pk_mul_f32 v[36:37], v[36:37], v[40:41]
  v_cvt_pk_bf16_f32 v38, v34, v35
  v_cvt_pk_bf16_f32 v39, v36, v37
  v_lshlrev_b32 v34, 16, v38
  v_and_b32 v35, 0xffff0000, v38
  v_lshlrev_b32 v36, 16, v39
  v_and_b32 v37, 0xffff0000, v39
  v_pk_add_f32 v[34:35], v[34:35], v[42:43]
  v_pk_add_f32 v[36:37], v[36:37], v[44:45]
  v_cvt_pk_bf16_f32 v38, v34, v35
  v_cvt_pk_bf16_f32 v39, v36, v37
  v_lshlrev_b32 v34, 16, v38
  v_and_b32 v35, 0xffff0000, v38
  v_lshlrev_b32 v36, 16, v39
  v_and_b32 v37, 0xffff0000, v39
  v_pk_mul_f32 v[128:129], v[128:129], v[152:153] op_sel:[0,0] op_sel_hi:[1,0]
  v_pk_mul_f32 v[34:35], v[34:35], v[152:153] op_sel:[0,1] op_sel_hi:[1,1]
  v_pk_mul_f32 v[130:131], v[130:131], v[152:153] op_sel:[0,0] op_sel_hi:[1,0]
  v_pk_mul_f32 v[36:37], v[36:37], v[152:153] op_sel:[0,1] op_sel_hi:[1,1]
  v_cvt_pk_bf16_f32 v38, v128, v129
  v_cvt_pk_bf16_f32 v40, v34, v35
  v_cvt_pk_bf16_f32 v39, v130, v131
  v_cvt_pk_bf16_f32 v41, v36, v37
  v_lshlrev_b32 v128, 16, v38
  v_and_b32 v129, 0xffff0000, v38
  v_lshlrev_b32 v34, 16, v40
  v_and_b32 v35, 0xffff0000, v40
  v_lshlrev_b32 v130, 16, v39
  v_and_b32 v131, 0xffff0000, v39
  v_lshlrev_b32 v36, 16, v41
  v_and_b32 v37, 0xffff0000, v41
  v_pk_add_f32 v[128:129], v[128:129], v[34:35]
  v_pk_add_f32 v[130:131], v[130:131], v[36:37]
  v_cvt_pk_bf16_f32 v96, v128, v129
  v_cvt_pk_bf16_f32 v97, v130, v131
  v_cvt_pk_bf16_f32 v48, v132, v133
  v_cvt_pk_bf16_f32 v49, v134, v135
  v_lshlrev_b32 v132, 16, v48
  v_and_b32 v133, 0xffff0000, v48
  v_lshlrev_b32 v134, 16, v49
  v_and_b32 v135, 0xffff0000, v49
  v_lshlrev_b32 v50, 16, v146
  v_and_b32 v51, 0xffff0000, v146
  v_lshlrev_b32 v52, 16, v147
  v_and_b32 v53, 0xffff0000, v147
  v_lshlrev_b32 v54, 16, v150
  v_and_b32 v55, 0xffff0000, v150
  v_lshlrev_b32 v56, 16, v151
  v_and_b32 v57, 0xffff0000, v151
  v_lshlrev_b32 v58, 16, v156
  v_and_b32 v59, 0xffff0000, v156
  v_lshlrev_b32 v60, 16, v157
  v_and_b32 v61, 0xffff0000, v157
  v_pk_mul_f32 v[50:51], v[50:51], v[54:55]
  v_pk_mul_f32 v[52:53], v[52:53], v[56:57]
  v_cvt_pk_bf16_f32 v54, v50, v51
  v_cvt_pk_bf16_f32 v55, v52, v53
  v_lshlrev_b32 v50, 16, v54
  v_and_b32 v51, 0xffff0000, v54
  v_lshlrev_b32 v52, 16, v55
  v_and_b32 v53, 0xffff0000, v55
  v_pk_add_f32 v[50:51], v[50:51], v[58:59]
  v_pk_add_f32 v[52:53], v[52:53], v[60:61]
  v_cvt_pk_bf16_f32 v54, v50, v51
  v_cvt_pk_bf16_f32 v55, v52, v53
  v_lshlrev_b32 v50, 16, v54
  v_and_b32 v51, 0xffff0000, v54
  v_lshlrev_b32 v52, 16, v55
  v_and_b32 v53, 0xffff0000, v55
  v_pk_mul_f32 v[132:133], v[132:133], v[152:153] op_sel:[0,0] op_sel_hi:[1,0]
  v_pk_mul_f32 v[50:51], v[50:51], v[152:153] op_sel:[0,1] op_sel_hi:[1,1]
  v_pk_mul_f32 v[134:135], v[134:135], v[152:153] op_sel:[0,0] op_sel_hi:[1,0]
  v_pk_mul_f32 v[52:53], v[52:53], v[152:153] op_sel:[0,1] op_sel_hi:[1,1]
  v_cvt_pk_bf16_f32 v54, v132, v133
  v_cvt_pk_bf16_f32 v56, v50, v51
  v_cvt_pk_bf16_f32 v55, v134, v135
  v_cvt_pk_bf16_f32 v57, v52, v53
  v_lshlrev_b32 v132, 16, v54
  v_and_b32 v133, 0xffff0000, v54
  v_lshlrev_b32 v50, 16, v56
  v_and_b32 v51, 0xffff0000, v56
  v_lshlrev_b32 v134, 16, v55
  v_and_b32 v135, 0xffff0000, v55
  v_lshlrev_b32 v52, 16, v57
  v_and_b32 v53, 0xffff0000, v57
  v_pk_add_f32 v[132:133], v[132:133], v[50:51]
  v_pk_add_f32 v[134:135], v[134:135], v[52:53]
  v_cvt_pk_bf16_f32 v98, v132, v133
  v_cvt_pk_bf16_f32 v99, v134, v135
  s_nop 0
  v_permlane32_swap_b32 v96, v98
  v_permlane32_swap_b32 v97, v99
  v_lshl_add_u32 v13, v4, 4, v6
  s_nop 1
  buffer_store_dwordx4 v[96:99], v13, s[20:23], s49 offen
LFA_exit:
  s_endpgm
LK1_exit:
  s_endpgm
LK1_B:
  s_sub_u32 s3, s2, 128
  s_load_dwordx2 s[40:41], s[0:1], 8
  s_and_b32 s4, s3, 7
  s_and_b32 s5, s3, 1
  s_mul_i32 s4, s4, 14
  s_lshr_b32 s3, s3, 3
  s_mul_i32 s43, s3, 86016
  s_mul_i32 s5, s5, 384
  s_add_u32 s43, s43, s5
  s_add_u32 s3, s3, s4
  s_load_dwordx8 s[16:23], s[0:1], 40
  s_load_dwordx4 s[24:27], s[0:1], 72
  s_load_dwordx2 s[28:29], s[0:1], 88
  s_load_dwordx4 s[32:35], s[0:1], 120
  s_load_dwordx2 s[36:37], s[0:1], 0
  v_and_b32 v1, 63, v0
  v_lshrrev_b32 v2, 6, v0
  s_nop 0
  v_readfirstlane_b32 s6, v2
  s_nop 0
  s_lshr_b32 s38, s6, 1
  s_and_b32 s39, s6, 1
  s_lshl_b32 s7, s3, 2
  s_add_u32 s7, s7, s38
  s_mul_i32 s42, s6, 8704
  v_lshlrev_b32 v5, 2, v1
  s_lshl_b32 s44, s7, 9
  s_lshl_b32 s45, s39, 8
  s_add_u32 s44, s44, s45
  v_add_u32 v5, s44, v5
  s_lshl_b32 s45, s7, 1
  v_mov_b32 v6, s45
  v_mul_u32_u24 v3, 3584, v0
  s_lshl_b32 s45, s3, 3
  s_waitcnt lgkmcnt(0)
  s_mov_b32 s8, s36
  s_mov_b32 s9, s37
  s_mov_b32 s10, 1835008
  s_mov_b32 s11, 0x00020000
  s_mov_b32 s12, s34
  s_mov_b32 s13, s35
  s_mov_b32 s14, 16777216
  s_mov_b32 s15, 0x00020000
  global_load_dword v16, v5, s[16:17]
  global_load_dword v17, v5, s[18:19]
  global_load_dword v18, v5, s[20:21]
  global_load_dword v19, v5, s[22:23]
  global_load_dword v20, v5, s[24:25]
  global_load_dword v21, v5, s[26:27]
  global_load_ushort v22, v6, s[28:29]
  s_mov_b32 s43, s45
  v_lshlrev_b32 v11, 2, v1
  v_add_u32 v11, s42, v11
  v_and_b32 v12, 31, v1
  v_mul_u32_u24 v12, 272, v12
  v_lshrrev_b32 v13, 5, v1
  v_lshl_add_u32 v12, v13, 4, v12
  v_add_u32 v12, s42, v12
  s_mov_b32 s47, 0x3fb8aa3b
  s_mov_b32 s48, 0x3e22f983
  s_waitcnt vmcnt(0)
  v_lshlrev_b32 v22, 16, v22
  v_mul_f32 v22, s47, v22
  v_exp_f32 v22, v22
  s_nop 0
  v_cvt_pk_bf16_f32 v22, v22, v22
  v_lshlrev_b32 v22, 16, v22
  v_mov_b32 v96, 0
  v_mov_b32 v97, 0
  v_mov_b32 v98, 0
  v_mov_b32 v99, 0
  v_mov_b32 v100, 0
  v_mov_b32 v101, 0
  v_mov_b32 v102, 0
  v_mov_b32 v103, 0
  v_mov_b32 v104, 0
  v_mov_b32 v105, 0
  v_mov_b32 v106, 0
  v_mov_b32 v107, 0
  v_mov_b32 v108, 0
  v_mov_b32 v109, 0
  v_mov_b32 v110, 0
  v_mov_b32 v111, 0
  s_mov_b32 s49, 0
LB_pass:
  v_lshlrev_b32 v32, 16, v16
  v_lshlrev_b32 v33, 16, v17
  v_lshlrev_b32 v34, 16, v18
  v_lshlrev_b32 v35, 16, v19
  v_lshlrev_b32 v48, 16, v20
  v_lshlrev_b32 v49, 16, v21
  v_mul_f32 v32, v32, v22
  v_mul_f32 v33, v33, v22
  v_mul_f32 v34, v34, v22
  v_mul_f32 v35, v35, v22
  v_mul_f32 v32, s47, v32
  v_mul_f32 v33, s48, v33
  v_pk_mul_f32 v[50:51], v[48:49], v[34:35] op_sel:[0,0] op_sel_hi:[1,0]
  v_pk_fma_f32 v[36:37], v[48:49], v[34:35], v[50:51] op_sel:[1,1,0] op_sel_hi:[0,1,1] neg_lo:[1,0,0]
  v_mul_f32 v48, 0x3f800000, v32
  v_mul_f32 v50, 0x41000000, v32
  v_mul_f32 v52, 0x43800000, v32
  v_mul_f32 v49, 0x3f800000, v33
  v_mul_f32 v51, 0x41000000, v33
  v_mul_f32 v53, 0x43800000, v33
  v_exp_f32 v48, v48
  v_exp_f32 v50, v50
  v_exp_f32 v52, v52
  v_fract_f32 v49, v49
  v_fract_f32 v51, v51
  v_fract_f32 v53, v53
  v_cos_f32 v38, v49
  v_cos_f32 v44, v51
  v_cos_f32 v46, v53
  v_sin_f32 v39, v49
  v_sin_f32 v45, v51
  v_sin_f32 v47, v53
  v_pk_mul_f32 v[38:39], v[38:39], v[48:49] op_sel:[0,0] op_sel_hi:[1,0]
  v_pk_mul_f32 v[44:45], v[44:45], v[50:51] op_sel:[0,0] op_sel_hi:[1,0]
  v_pk_mul_f32 v[46:47], v[46:47], v[52:53] op_sel:[0,0] op_sel_hi:[1,0]
  v_pk_mul_f32 v[48:49], v[38:39], v[38:39] op_sel:[0,0] op_sel_hi:[1,0]
  v_pk_fma_f32 v[40:41], v[38:39], v[38:39], v[48:49] op_sel:[1,1,0] op_sel_hi:[0,1,1] neg_lo:[1,0,0]
  v_pk_mul_f32 v[48:49], v[40:41], v[40:41] op_sel:[0,0] op_sel_hi:[1,0]
  v_pk_fma_f32 v[42:43], v[40:41], v[40:41], v[48:49] op_sel:[1,1,0] op_sel_hi:[0,1,1] neg_lo:[1,0,0]
  v_pk_mul_f32 v[50:51], v[36:37], v[46:47] op_sel:[0,0] op_sel_hi:[1,0]
  v_pk_fma_f32 v[68:69], v[36:37], v[46:47], v[50:51] op_sel:[1,1,0] op_sel_hi:[0,1,1] neg_lo:[1,0,0]
  v_pk_mul_f32 v[50:51], v[68:69], v[46:47] op_sel:[0,0] op_sel_hi:[1,0]
  v_pk_fma_f32 v[70:71], v[68:69], v[46:47], v[50:51] op_sel:[1,1,0] op_sel_hi:[0,1,1] neg_lo:[1,0,0]
  v_pk_mul_f32 v[50:51], v[70:71], v[46:47] op_sel:[0,0] op_sel_hi:[1,0]
  v_pk_fma_f32 v[72:73], v[70:71], v[46:47], v[50:51] op_sel:[1,1,0] op_sel_hi:[0,1,1] neg_lo:[1,0,0]
  v_cvt_pk_bf16_f32 v64, v36, v37
  v_cvt_pk_bf16_f32 v65, v68, v69
  v_cvt_pk_bf16_f32 v66, v70, v71
  v_pk_mul_f32 v[76:77], v[72:73], v[46:47] op_sel:[0,0] op_sel_hi:[1,0]
  ds_write_b32 v11, v64 offset:0
  ds_write_b32 v11, v65 offset:2176
  ds_write_b32 v11, v66 offset:4352
  v_pk_fma_f32 v[74:75], v[72:73], v[46:47], v[76:77] op_sel:[1,1,0] op_sel_hi:[0,1,1] neg_lo:[1,0,0]
  v_pk_mul_f32 v[48:49], v[36:37], v[38:39] op_sel:[0,0] op_sel_hi:[1,0]
  v_pk_mul_f32 v[50:51], v[68:69], v[40:41] op_sel:[0,0] op_sel_hi:[1,0]
  v_pk_mul_f32 v[52:53], v[70:71], v[42:43] op_sel:[0,0] op_sel_hi:[1,0]
  v_cvt_pk_bf16_f32 v67, v74, v75
  v_pk_fma_f32 v[54:55], v[36:37], v[38:39], v[48:49] op_sel:[1,1,0] op_sel_hi:[0,1,1] neg_lo:[1,0,0]
  v_pk_fma_f32 v[56:57], v[68:69], v[40:41], v[50:51] op_sel:[1,1,0] op_sel_hi:[0,1,1] neg_lo:[1,0,0]
  v_pk_fma_f32 v[58:59], v[70:71], v[42:43], v[52:53] op_sel:[1,1,0] op_sel_hi:[0,1,1] neg_lo:[1,0,0]
  ds_write_b32 v11, v67 offset:6528
  v_cvt_pk_bf16_f32 v64, v54, v55
  v_cvt_pk_bf16_f32 v65, v56, v57
  v_cvt_pk_bf16_f32 v66, v58, v59
  v_pk_mul_f32 v[76:77], v[74:75], v[44:45] op_sel:[0,0] op_sel_hi:[1,0]
  ds_write_b32 v11, v64 offset:272
  ds_write_b32 v11, v65 offset:2448
  ds_write_b32 v11, v66 offset:4624
  v_pk_fma_f32 v[60:61], v[74:75], v[44:45], v[76:77] op_sel:[1,1,0] op_sel_hi:[0,1,1] neg_lo:[1,0,0]
  v_pk_mul_f32 v[48:49], v[54:55], v[38:39] op_sel:[0,0] op_sel_hi:[1,0]
  v_pk_mul_f32 v[50:51], v[56:57], v[40:41] op_sel:[0,0] op_sel_hi:[1,0]
  ds_write_b32 v11, v66 offset:5440
  v_cvt_pk_bf16_f32 v67, v60, v61
  v_pk_fma_f32 v[54:55], v[54:55], v[38:39], v[48:49] op_sel:[1,1,0] op_sel_hi:[0,1,1] neg_lo:[1,0,0]
  v_pk_fma_f32 v[56:57], v[56:57], v[40:41], v[50:51] op_sel:[1,1,0] op_sel_hi:[0,1,1] neg_lo:[1,0,0]
  v_pk_mul_f32 v[52:53], v[58:59], v[42:43] op_sel:[0,0] op_sel_hi:[1,0]
  ds_write_b32 v11, v67 offset:7616
  v_cvt_pk_bf16_f32 v64, v54, v55
  v_cvt_pk_bf16_f32 v65, v56, v57
  v_pk_fma_f32 v[58:59], v[58:59], v[42:43], v[52:53] op_sel:[1,1,0] op_sel_hi:[0,1,1] neg_lo:[1,0,0]
  v_pk_mul_f32 v[76:77], v[74:75], v[46:47] op_sel:[0,0] op_sel_hi:[1,0]
  ds_write_b32 v11, v64 offset:544
  ds_write_b32 v11, v65 offset:2720
  v_cvt_pk_bf16_f32 v66, v58, v59
  v_pk_fma_f32 v[74:75], v[74:75], v[46:47], v[76:77] op_sel:[1,1,0] op_sel_hi:[0,1,1] neg_lo:[1,0,0]
  v_pk_mul_f32 v[48:49], v[54:55], v[38:39] op_sel:[0,0] op_sel_hi:[1,0]
  ds_write_b32 v11, v65 offset:3264
  ds_write_b32 v11, v66 offset:5712
  v_cvt_pk_bf16_f32 v67, v74, v75
  v_pk_fma_f32 v[54:55], v[54:55], v[38:39], v[48:49] op_sel:[1,1,0] op_sel_hi:[0,1,1] neg_lo:[1,0,0]
  v_pk_mul_f32 v[50:51], v[56:57], v[40:41] op_sel:[0,0] op_sel_hi:[1,0]
  v_cvt_pk_bf16_f32 v66, v72, v73
  ds_write_b32 v11, v67 offset:6800
  v_cvt_pk_bf16_f32 v64, v54, v55
  v_pk_fma_f32 v[56:57], v[56:57], v[40:41], v[50:51] op_sel:[1,1,0] op_sel_hi:[0,1,1] neg_lo:[1,0,0]
  ds_write_b32 v11, v66 offset:4896
  v_pk_mul_f32 v[76:77], v[74:75], v[44:45] op_sel:[0,0] op_sel_hi:[1,0]
  ds_write_b32 v11, v64 offset:816
  v_cvt_pk_bf16_f32 v65, v56, v57
  v_pk_mul_f32 v[52:53], v[72:73], v[42:43] op_sel:[0,0] op_sel_hi:[1,0]
  v_pk_fma_f32 v[60:61], v[74:75], v[44:45], v[76:77] op_sel:[1,1,0] op_sel_hi:[0,1,1] neg_lo:[1,0,0]
  v_pk_mul_f32 v[48:49], v[54:55], v[38:39] op_sel:[0,0] op_sel_hi:[1,0]
  ds_write_b32 v11, v65 offset:3536
  v_pk_fma_f32 v[58:59], v[72:73], v[42:43], v[52:53] op_sel:[1,1,0] op_sel_hi:[0,1,1] neg_lo:[1,0,0]
  v_cvt_pk_bf16_f32 v67, v60, v61
  v_pk_fma_f32 v[54:55], v[54:55], v[38:39], v[48:49] op_sel:[1,1,0] op_sel_hi:[0,1,1] neg_lo:[1,0,0]
  v_pk_mul_f32 v[50:51], v[56:57], v[40:41] op_sel:[0,0] op_sel_hi:[1,0]
  v_cvt_pk_bf16_f32 v66, v58, v59
  ds_write_b32 v11, v67 offset:7888
  v_cvt_pk_bf16_f32 v64, v54, v55
  v_pk_fma_f32 v[56:57], v[56:57], v[40:41], v[50:51] op_sel:[1,1,0] op_sel_hi:[0,1,1] neg_lo:[1,0,0]
  ds_write_b32 v11, v66 offset:5168
  v_pk_mul_f32 v[76:77], v[74:75], v[46:47] op_sel:[0,0] op_sel_hi:[1,0]
  ds_write_b32 v11, v64 offset:1088
  v_cvt_pk_bf16_f32 v65, v56, v57
  ds_write_b32 v11, v66 offset:5984
  v_pk_fma_f32 v[74:75], v[74:75], v[46:47], v[76:77] op_sel:[1,1,0] op_sel_hi:[0,1,1] neg_lo:[1,0,0]
  v_pk_mul_f32 v[48:49], v[54:55], v[38:39] op_sel:[0,0] op_sel_hi:[1,0]
  ds_write_b32 v11, v65 offset:3808
  v_pk_mul_f32 v[52:53], v[58:59], v[42:43] op_sel:[0,0] op_sel_hi:[1,0]
  v_cvt_pk_bf16_f32 v67, v74, v75
  v_pk_fma_f32 v[54:55], v[54:55], v[38:39], v[48:49] op_sel:[1,1,0] op_sel_hi:[0,1,1] neg_lo:[1,0,0]
  v_pk_fma_f32 v[58:59], v[58:59], v[42:43], v[52:53] op_sel:[1,1,0] op_sel_hi:[0,1,1] neg_lo:[1,0,0]
  ds_write_b32 v11, v67 offset:7072
  v_cvt_pk_bf16_f32 v64, v54, v55
  v_cvt_pk_bf16_f32 v66, v58, v59
  v_pk_mul_f32 v[76:77], v[74:75], v[44:45] op_sel:[0,0] op_sel_hi:[1,0]
  ds_write_b32 v11, v64 offset:1360
  ds_write_b32 v11, v66 offset:6256
  v_pk_fma_f32 v[60:61], v[74:75], v[44:45], v[76:77] op_sel:[1,1,0] op_sel_hi:[0,1,1] neg_lo:[1,0,0]
  v_pk_mul_f32 v[48:49], v[54:55], v[38:39] op_sel:[0,0] op_sel_hi:[1,0]
  v_cvt_pk_bf16_f32 v67, v60, v61
  v_pk_fma_f32 v[54:55], v[54:55], v[38:39], v[48:49] op_sel:[1,1,0] op_sel_hi:[0,1,1] neg_lo:[1,0,0]
  ds_write_b32 v11, v67 offset:8160
  v_cvt_pk_bf16_f32 v64, v54, v55
  v_pk_mul_f32 v[76:77], v[74:75], v[46:47] op_sel:[0,0] op_sel_hi:[1,0]
  ds_write_b32 v11, v64 offset:1632
  v_pk_fma_f32 v[74:75], v[74:75], v[46:47], v[76:77] op_sel:[1,1,0] op_sel_hi:[0,1,1] neg_lo:[1,0,0]
  v_pk_mul_f32 v[48:49], v[54:55], v[38:39] op_sel:[0,0] op_sel_hi:[1,0]
  v_cvt_pk_bf16_f32 v67, v74, v75
  v_pk_fma_f32 v[54:55], v[54:55], v[38:39], v[48:49] op_sel:[1,1,0] op_sel_hi:[0,1,1] neg_lo:[1,0,0]
  ds_write_b32 v11, v67 offset:7344
  v_cvt_pk_bf16_f32 v64, v54, v55
  v_pk_mul_f32 v[76:77], v[74:75], v[44:45] op_sel:[0,0] op_sel_hi:[1,0]
  ds_write_b32 v11, v64 offset:1904
  v_pk_fma_f32 v[60:61], v[74:75], v[44:45], v[76:77] op_sel:[1,1,0] op_sel_hi:[0,1,1] neg_lo:[1,0,0]
  v_cvt_pk_bf16_f32 v67, v60, v61
  ds_write_b32 v11, v67 offset:8432
  s_waitcnt lgkmcnt(0)
  ds_read_b128 v[112:115], v12 offset:0
  ds_read_b128 v[116:119], v12 offset:32
  ds_read_b128 v[120:123], v12 offset:64
  ds_read_b128 v[124:127], v12 offset:96
  ds_read_b128 v[128:131], v12 offset:128
  ds_read_b128 v[132:135], v12 offset:160
  ds_read_b128 v[136:139], v12 offset:192
  ds_read_b128 v[140:143], v12 offset:224
  v_pk_mul_f32 v[48:49], v[44:45], v[44:45] op_sel:[0,0] op_sel_hi:[1,0]
  v_pk_fma_f32 v[36:37], v[44:45], v[44:45], v[48:49] op_sel:[1,1,0] op_sel_hi:[0,1,1] neg_lo:[1,0,0]
  v_pk_mul_f32 v[48:49], v[36:37], v[36:37] op_sel:[0,0] op_sel_hi:[1,0]
  v_pk_fma_f32 v[38:39], v[36:37], v[36:37], v[48:49] op_sel:[1,1,0] op_sel_hi:[0,1,1] neg_lo:[1,0,0]
  v_pk_mul_f32 v[48:49], v[38:39], v[38:39] op_sel:[0,0] op_sel_hi:[1,0]
  v_pk_fma_f32 v[40:41], v[38:39], v[38:39], v[48:49] op_sel:[1,1,0] op_sel_hi:[0,1,1] neg_lo:[1,0,0]
  v_pk_mul_f32 v[48:49], v[40:41], v[40:41] op_sel:[0,0] op_sel_hi:[1,0]
  v_pk_fma_f32 v[46:47], v[40:41], v[40:41], v[48:49] op_sel:[1,1,0] op_sel_hi:[0,1,1] neg_lo:[1,0,0]
  v_pk_mul_f32 v[48:49], v[46:47], v[40:41] op_sel:[0,0] op_sel_hi:[1,0]
  v_pk_fma_f32 v[68:69], v[46:47], v[40:41], v[48:49] op_sel:[1,1,0] op_sel_hi:[0,1,1] neg_lo:[1,0,0]
  v_mov_b32 v42, v40
  v_xor_b32 v43, 0x80000000, v41
  v_xor_b32 v47, 0x80000000, v47
  v_xor_b32 v69, 0x80000000, v69
  v_mov_b32 v54, 1.0
  v_mov_b32 v55, 0
  s_waitcnt lgkmcnt(0)
  v_cvt_pk_bf16_f32 v64, v54, v55
  v_cvt_pk_bf16_f32 v65, v42, v43
  v_cvt_pk_bf16_f32 v66, v46, v47
  v_cvt_pk_bf16_f32 v67, v68, v69
  ds_write_b32 v11, v64 offset:0
  ds_write_b32 v11, v65 offset:2176
  ds_write_b32 v11, v66 offset:4352
  ds_write_b32 v11, v67 offset:6528
  v_pk_mul_f32 v[48:49], v[54:55], v[44:45] op_sel:[0,0] op_sel_hi:[1,0]
  v_pk_mul_f32 v[50:51], v[42:43], v[44:45] op_sel:[0,0] op_sel_hi:[1,0]
  v_pk_mul_f32 v[52:53], v[46:47], v[44:45] op_sel:[0,0] op_sel_hi:[1,0]
  v_pk_mul_f32 v[76:77], v[68:69], v[44:45] op_sel:[0,0] op_sel_hi:[1,0]
  v_pk_fma_f32 v[54:55], v[54:55], v[44:45], v[48:49] op_sel:[1,1,0] op_sel_hi:[0,1,1] neg_hi:[1,0,0]
  v_pk_fma_f32 v[56:57], v[42:43], v[44:45], v[50:51] op_sel:[1,1,0] op_sel_hi:[0,1,1] neg_hi:[1,0,0]
  v_pk_fma_f32 v[58:59], v[46:47], v[44:45], v[52:53] op_sel:[1,1,0] op_sel_hi:[0,1,1] neg_hi:[1,0,0]
  v_pk_fma_f32 v[60:61], v[68:69], v[44:45], v[76:77] op_sel:[1,1,0] op_sel_hi:[0,1,1] neg_hi:[1,0,0]
  v_cvt_pk_bf16_f32 v64, v54, v55
  v_cvt_pk_bf16_f32 v65, v56, v57
  v_cvt_pk_bf16_f32 v66, v58, v59
  v_cvt_pk_bf16_f32 v67, v60, v61
  ds_write_b32 v11, v64 offset:272
  ds_write_b32 v11, v65 offset:2448
  ds_write_b32 v11, v66 offset:4624
  ds_write_b32 v11, v67 offset:6800
  v_pk_mul_f32 v[48:49], v[54:55], v[44:45] op_sel:[0,0] op_sel_hi:[1,0]
  v_pk_mul_f32 v[50:51], v[56:57], v[44:45] op_sel:[0,0] op_sel_hi:[1,0]
  v_pk_mul_f32 v[52:53], v[58:59], v[44:45] op_sel:[0,0] op_sel_hi:[1,0]
  v_pk_mul_f32 v[76:77], v[60:61], v[44:45] op_sel:[0,0] op_sel_hi:[1,0]
  v_pk_fma_f32 v[54:55], v[54:55], v[44:45], v[48:49] op_sel:[1,1,0] op_sel_hi:[0,1,1] neg_hi:[1,0,0]
  v_pk_fma_f32 v[56:57], v[56:57], v[44:45], v[50:51] op_sel:[1,1,0] op_sel_hi:[0,1,1] neg_hi:[1,0,0]
  v_pk_fma_f32 v[58:59], v[58:59], v[44:45], v[52:53] op_sel:[1,1,0] op_sel_hi:[0,1,1] neg_hi:[1,0,0]
  v_pk_fma_f32 v[60:61], v[60:61], v[44:45], v[76:77] op_sel:[1,1,0] op_sel_hi:[0,1,1] neg_hi:[1,0,0]
  v_cvt_pk_bf16_f32 v64, v54, v55
  v_cvt_pk_bf16_f32 v65, v56, v57
  v_cvt_pk_bf16_f32 v66, v58, v59
  v_cvt_pk_bf16_f32 v67, v60, v61
  ds_write_b32 v11, v64 offset:544
  ds_write_b32 v11, v65 offset:2720
  ds_write_b32 v11, v66 offset:4896
  ds_write_b32 v11, v67 offset:7072
  v_pk_mul_f32 v[48:49], v[54:55], v[44:45] op_sel:[0,0] op_sel_hi:[1,0]
  v_pk_mul_f32 v[50:51], v[56:57], v[44:45] op_sel:[0,0] op_sel_hi:[1,0]
  v_pk_mul_f32 v[52:53], v[58:59], v[44:45] op_sel:[0,0] op_sel_hi:[1,0]
  v_pk_mul_f32 v[76:77], v[60:61], v[44:45] op_sel:[0,0] op_sel_hi:[1,0]
  v_pk_fma_f32 v[54:55], v[54:55], v[44:45], v[48:49] op_sel:[1,1,0] op_sel_hi:[0,1,1] neg_hi:[1,0,0]
  v_pk_fma_f32 v[56:57], v[56:57], v[44:45], v[50:51] op_sel:[1,1,0] op_sel_hi:[0,1,1] neg_hi:[1,0,0]
  v_pk_fma_f32 v[58:59], v[58:59], v[44:45], v[52:53] op_sel:[1,1,0] op_sel_hi:[0,1,1] neg_hi:[1,0,0]
  v_pk_fma_f32 v[60:61], v[60:61], v[44:45], v[76:77] op_sel:[1,1,0] op_sel_hi:[0,1,1] neg_hi:[1,0,0]
  v_cvt_pk_bf16_f32 v64, v54, v55
  v_cvt_pk_bf16_f32 v65, v56, v57
  v_cvt_pk_bf16_f32 v66, v58, v59
  v_cvt_pk_bf16_f32 v67, v60, v61
  ds_write_b32 v11, v64 offset:816
  ds_write_b32 v11, v65 offset:2992
  ds_write_b32 v11, v66 offset:5168
  ds_write_b32 v11, v67 offset:7344
  v_pk_mul_f32 v[48:49], v[54:55], v[44:45] op_sel:[0,0] op_sel_hi:[1,0]
  v_pk_mul_f32 v[50:51], v[56:57], v[44:45] op_sel:[0,0] op_sel_hi:[1,0]
  v_pk_mul_f32 v[52:53], v[58:59], v[44:45] op_sel:[0,0] op_sel_hi:[1,0]
  v_pk_mul_f32 v[76:77], v[60:61], v[44:45] op_sel:[0,0] op_sel_hi:[1,0]
  v_pk_fma_f32 v[54:55], v[54:55], v[44:45], v[48:49] op_sel:[1,1,0] op_sel_hi:[0,1,1] neg_hi:[1,0,0]
  v_pk_fma_f32 v[56:57], v[56:57], v[44:45], v[50:51] op_sel:[1,1,0] op_sel_hi:[0,1,1] neg_hi:[1,0,0]
  v_pk_fma_f32 v[58:59], v[58:59], v[44:45], v[52:53] op_sel:[1,1,0] op_sel_hi:[0,1,1] neg_hi:[1,0,0]
  v_pk_fma_f32 v[60:61], v[60:61], v[44:45], v[76:77] op_sel:[1,1,0] op_sel_hi:[0,1,1] neg_hi:[1,0,0]
  v_cvt_pk_bf16_f32 v64, v54, v55
  v_cvt_pk_bf16_f32 v65, v56, v57
  v_cvt_pk_bf16_f32 v66, v58, v59
  v_cvt_pk_bf16_f32 v67, v60, v61
  ds_write_b32 v11, v64 offset:1088
  ds_write_b32 v11, v65 offset:3264
  ds_write_b32 v11, v66 offset:5440
  ds_write_b32 v11, v67 offset:7616
  v_pk_mul_f32 v[48:49], v[54:55], v[44:45] op_sel:[0,0] op_sel_hi:[1,0]
  v_pk_mul_f32 v[50:51], v[56:57], v[44:45] op_sel:[0,0] op_sel_hi:[1,0]
  v_pk_mul_f32 v[52:53], v[58:59], v[44:45] op_sel:[0,0] op_sel_hi:[1,0]
  v_pk_mul_f32 v[76:77], v[60:61], v[44:45] op_sel:[0,0] op_sel_hi:[1,0]
  v_pk_fma_f32 v[54:55], v[54:55], v[44:45], v[48:49] op_sel:[1,1,0] op_sel_hi:[0,1,1] neg_hi:[1,0,0]
  v_pk_fma_f32 v[56:57], v[56:57], v[44:45], v[50:51] op_sel:[1,1,0] op_sel_hi:[0,1,1] neg_hi:[1,0,0]
  v_pk_fma_f32 v[58:59], v[58:59], v[44:45], v[52:53] op_sel:[1,1,0] op_sel_hi:[0,1,1] neg_hi:[1,0,0]
  v_pk_fma_f32 v[60:61], v[60:61], v[44:45], v[76:77] op_sel:[1,1,0] op_sel_hi:[0,1,1] neg_hi:[1,0,0]
  v_cvt_pk_bf16_f32 v64, v54, v55
  v_cvt_pk_bf16_f32 v65, v56, v57
  v_cvt_pk_bf16_f32 v66, v58, v59
  v_cvt_pk_bf16_f32 v67, v60, v61
  ds_write_b32 v11, v64 offset:1360
  ds_write_b32 v11, v65 offset:3536
  ds_write_b32 v11, v66 offset:5712
  ds_write_b32 v11, v67 offset:7888
  v_pk_mul_f32 v[48:49], v[54:55], v[44:45] op_sel:[0,0] op_sel_hi:[1,0]
  v_pk_mul_f32 v[50:51], v[56:57], v[44:45] op_sel:[0,0] op_sel_hi:[1,0]
  v_pk_mul_f32 v[52:53], v[58:59], v[44:45] op_sel:[0,0] op_sel_hi:[1,0]
  v_pk_mul_f32 v[76:77], v[60:61], v[44:45] op_sel:[0,0] op_sel_hi:[1,0]
  v_pk_fma_f32 v[54:55], v[54:55], v[44:45], v[48:49] op_sel:[1,1,0] op_sel_hi:[0,1,1] neg_hi:[1,0,0]
  v_pk_fma_f32 v[56:57], v[56:57], v[44:45], v[50:51] op_sel:[1,1,0] op_sel_hi:[0,1,1] neg_hi:[1,0,0]
  v_pk_fma_f32 v[58:59], v[58:59], v[44:45], v[52:53] op_sel:[1,1,0] op_sel_hi:[0,1,1] neg_hi:[1,0,0]
  v_pk_fma_f32 v[60:61], v[60:61], v[44:45], v[76:77] op_sel:[1,1,0] op_sel_hi:[0,1,1] neg_hi:[1,0,0]
  v_cvt_pk_bf16_f32 v64, v54, v55
  v_cvt_pk_bf16_f32 v65, v56, v57
  v_cvt_pk_bf16_f32 v66, v58, v59
  v_cvt_pk_bf16_f32 v67, v60, v61
  ds_write_b32 v11, v64 offset:1632
  ds_write_b32 v11, v65 offset:3808
  ds_write_b32 v11, v66 offset:5984
  ds_write_b32 v11, v67 offset:8160
  v_pk_mul_f32 v[48:49], v[54:55], v[44:45] op_sel:[0,0] op_sel_hi:[1,0]
  v_pk_mul_f32 v[50:51], v[56:57], v[44:45] op_sel:[0,0] op_sel_hi:[1,0]
  v_pk_mul_f32 v[52:53], v[58:59], v[44:45] op_sel:[0,0] op_sel_hi:[1,0]
  v_pk_mul_f32 v[76:77], v[60:61], v[44:45] op_sel:[0,0] op_sel_hi:[1,0]
  v_pk_fma_f32 v[54:55], v[54:55], v[44:45], v[48:49] op_sel:[1,1,0] op_sel_hi:[0,1,1] neg_hi:[1,0,0]
  v_pk_fma_f32 v[56:57], v[56:57], v[44:45], v[50:51] op_sel:[1,1,0] op_sel_hi:[0,1,1] neg_hi:[1,0,0]
  v_pk_fma_f32 v[58:59], v[58:59], v[44:45], v[52:53] op_sel:[1,1,0] op_sel_hi:[0,1,1] neg_hi:[1,0,0]
  v_pk_fma_f32 v[60:61], v[60:61], v[44:45], v[76:77] op_sel:[1,1,0] op_sel_hi:[0,1,1] neg_hi:[1,0,0]
  v_cvt_pk_bf16_f32 v64, v54, v55
  v_cvt_pk_bf16_f32 v65, v56, v57
  v_cvt_pk_bf16_f32 v66, v58, v59
  v_cvt_pk_bf16_f32 v67, v60, v61
  ds_write_b32 v11, v64 offset:1904
  ds_write_b32 v11, v65 offset:4080
  ds_write_b32 v11, v66 offset:6256
  ds_write_b32 v11, v67 offset:8432
  s_waitcnt lgkmcnt(0)
  ds_read_b128 v[144:147], v12 offset:0
  ds_read_b128 v[148:151], v12 offset:32
  ds_read_b128 v[152:155], v12 offset:64
  ds_read_b128 v[156:159], v12 offset:96
  ds_read_b128 v[160:163], v12 offset:128
  ds_read_b128 v[164:167], v12 offset:160
  ds_read_b128 v[168:171], v12 offset:192
  ds_read_b128 v[172:175], v12 offset:224
  s_waitcnt lgkmcnt(7)
  v_mfma_f32_32x32x16_bf16 v[96:111], v[112:115], v[144:147], v[96:111]
  s_waitcnt lgkmcnt(6)
  v_mfma_f32_32x32x16_bf16 v[96:111], v[116:119], v[148:151], v[96:111]
  s_waitcnt lgkmcnt(5)
  v_mfma_f32_32x32x16_bf16 v[96:111], v[120:123], v[152:155], v[96:111]
  s_waitcnt lgkmcnt(4)
  v_mfma_f32_32x32x16_bf16 v[96:111], v[124:127], v[156:159], v[96:111]
  s_waitcnt lgkmcnt(3)
  v_mfma_f32_32x32x16_bf16 v[96:111], v[128:131], v[160:163], v[96:111]
  s_waitcnt lgkmcnt(2)
  v_mfma_f32_32x32x16_bf16 v[96:111], v[132:135], v[164:167], v[96:111]
  s_waitcnt lgkmcnt(1)
  v_mfma_f32_32x32x16_bf16 v[96:111], v[136:139], v[168:171], v[96:111]
  s_waitcnt lgkmcnt(0)
  v_mfma_f32_32x32x16_bf16 v[96:111], v[140:143], v[172:175], v[96:111]
  v_lshrrev_b32 v16, 16, v16
  v_lshrrev_b32 v17, 16, v17
  v_lshrrev_b32 v18, 16, v18
  v_lshrrev_b32 v19, 16, v19
  v_lshrrev_b32 v20, 16, v20
  v_lshrrev_b32 v21, 16, v21
  s_cmp_lg_u32 s49, 0
  s_cbranch_scc1 LB_nogather
  buffer_load_dwordx2 v[80:81], v3, s[8:11], s43 offen
  buffer_load_dwordx2 v[82:83], v3, s[8:11], s43 offen offset:896
  buffer_load_dwordx2 v[84:85], v3, s[8:11], s43 offen offset:1792
  buffer_load_dwordx2 v[86:87], v3, s[8:11], s43 offen offset:2688
LB_nogather:
  s_add_u32 s49, s49, 1
  s_cmp_lt_u32 s49, 2
  s_cbranch_scc1 LB_pass
  v_lshlrev_b32 v2, 4, v1
  s_lshl_b32 s45, s6, 11
  s_add_u32 s45, s45, 88064
  v_add_u32 v3, s45, v2
  s_xor_b32 s46, s6, 1
  s_lshl_b32 s46, s46, 11
  s_add_u32 s46, s46, 88064
  v_add_u32 v4, s46, v2
  s_nop 7
  s_nop 7
  s_cmp_eq_u32 s39, 0
  s_cbranch_scc1 LB_ex0
  ds_write_b128 v3, v[96:99]
  ds_write_b128 v3, v[100:103] offset:1024
  s_branch LB_ex1
LB_ex0:
  ds_write_b128 v3, v[104:107]
  ds_write_b128 v3, v[108:111] offset:1024
LB_ex1:
  s_waitcnt lgkmcnt(0)
  s_barrier
  ds_read_b128 v[24:27], v4
  ds_read_b128 v[28:31], v4 offset:1024
  s_mov_b32 s45, 0x05040100
  s_mov_b32 s46, 0x07060302
  s_waitcnt vmcnt(0)
  v_perm_b32 v88, v82, v80, s45
  v_perm_b32 v89, v86, v84, s45
  v_perm_b32 v90, v82, v80, s46
  v_perm_b32 v91, v86, v84, s46
  v_perm_b32 v92, v83, v81, s45
  v_perm_b32 v93, v87, v85, s45
  v_perm_b32 v94, v83, v81, s46
  v_perm_b32 v95, v87, v85, s46
  v_lshlrev_b32 v8, 3, v0
  v_add_u32 v8, 70144, v8
  ds_write_b64 v8, v[88:89]
  ds_write_b64 v8, v[90:91] offset:4608
  ds_write_b64 v8, v[92:93] offset:9216
  ds_write_b64 v8, v[94:95] offset:13824
  v_and_b32 v9, 31, v1
  v_lshrrev_b32 v10, 5, v1
  s_mul_i32 s46, s38, 17408
  v_lshlrev_b32 v13, 4, v9
  v_lshl_add_u32 v13, v10, 3, v13
  v_sub_u32 v13, 4088, v13
  v_add_u32 v13, s46, v13
  v_cmp_eq_u32 s[52:53], 1, v10
  s_cmp_eq_u32 s39, 1
  s_waitcnt lgkmcnt(4)
  s_cbranch_scc1 LB_w1
  v_add_f32 v24, v24, v96
  v_add_f32 v25, v25, v97
  v_add_f32 v26, v26, v98
  v_add_f32 v27, v27, v99
  v_add_f32 v28, v28, v100
  v_add_f32 v29, v29, v101
  v_add_f32 v30, v30, v102
  v_add_f32 v31, v31, v103
  v_cvt_pk_bf16_f32 v32, v27, v26
  v_cvt_pk_bf16_f32 v33, v25, v24
  v_cvt_pk_bf16_f32 v34, v30, v29
  v_cvt_pk_bf16_f32 v35, v28, v28
  v_subrev_u32 v14, 512, v13
  ds_write_b64 v13, v[32:33]
  ds_write_b64 v14, v[34:35]
  v_mov_b32 v36, 0
  v_mov_b32 v37, 0
  v_lshlrev_b32 v14, 3, v1
  v_add_u32 v14, s46, v14
  s_mov_b64 s[50:51], exec
  s_mov_b64 exec, 0xff
  ds_write_b64 v14, v[36:37] offset:4096
  s_mov_b64 exec, s[50:51]
  s_branch LB_w2
LB_w1:
  v_add_f32 v24, v24, v104
  v_add_f32 v25, v25, v105
  v_add_f32 v26, v26, v106
  v_add_f32 v27, v27, v107
  v_add_f32 v28, v28, v108
  v_add_f32 v29, v29, v109
  v_add_f32 v30, v30, v110
  v_add_f32 v31, v31, v111
  v_cndmask_b32 v32, v24, v25, s[52:53]
  v_cndmask_b32 v33, v26, v27, s[52:53]
  v_cvt_pk_bf16_f32 v34, v25, v32
  v_cvt_pk_bf16_f32 v35, v24, v24
  v_cvt_pk_bf16_f32 v36, v27, v33
  v_cvt_pk_bf16_f32 v37, v26, v26
  v_subrev_u32 v14, 1024, v13
  ds_write_b64 v14, v[34:35]
  v_subrev_u32 v14, 1536, v13
  ds_write_b64 v14, v[36:37]
  v_and_b32 v14, 1, v9
  v_and_b32 v14, v14, v10
  v_cmp_eq_u32 s[54:55], 1, v14
  v_mov_b32 v38, v28
  v_mov_b32 v39, v28
  s_nop 1
  v_permlane32_swap_b32 v38, v39
  v_cndmask_b32 v38, v38, v28, s[54:55]
  v_cvt_pk_bf16_f32 v40, v28, v28
  v_cvt_pk_bf16_f32 v41, v28, v38
  v_subrev_u32 v14, 2048, v13
  ds_write_b64 v14, v[40:41]
  v_mov_b32 v38, v29
  v_mov_b32 v39, v29
  s_nop 1
  v_permlane32_swap_b32 v38, v39
  v_cndmask_b32 v38, v38, v29, s[54:55]
  v_cvt_pk_bf16_f32 v42, v29, v29
  v_cvt_pk_bf16_f32 v43, v29, v38
  v_subrev_u32 v14, 2560, v13
  ds_write_b64 v14, v[42:43]
  v_mov_b32 v38, v30
  v_mov_b32 v39, v30
  s_nop 1
  v_permlane32_swap_b32 v38, v39
  v_cndmask_b32 v38, v38, v30, s[54:55]
  v_cvt_pk_bf16_f32 v44, v30, v30
  v_cvt_pk_bf16_f32 v45, v30, v38
  v_subrev_u32 v14, 3072, v13
  ds_write_b64 v14, v[44:45]
  v_mov_b32 v38, v31
  v_mov_b32 v39, v31
  s_nop 1
  v_permlane32_swap_b32 v38, v39
  v_cndmask_b32 v38, v38, v31, s[54:55]
  v_cvt_pk_bf16_f32 v46, v31, v31
  v_cvt_pk_bf16_f32 v47, v31, v38
  v_subrev_u32 v14, 3584, v13
  ds_write_b64 v14, v[46:47]
LB_w2:
  v_mov_b32 v36, 0
  v_mov_b32 v37, 0
  v_mov_b32 v38, 0
  v_mov_b32 v39, 0
  v_lshrrev_b32 v5, 5, v0
  v_and_b32 v6, 31, v0
  v_mul_u32_u24 v14, 4608, v5
  v_lshl_add_u32 v14, v6, 4, v14
  v_add_u32 v14, 69632, v14
  v_cmp_gt_u32 vcc, 128, v0
  s_nop 0
  s_and_saveexec_b64 s[50:51], vcc
  ds_write_b128 v14, v[36:39]
  s_mov_b64 exec, s[50:51]
  s_waitcnt lgkmcnt(0)
  s_barrier
  s_cmp_ge_u32 s2, 224
  s_cbranch_scc1 LB_nowo
  v_lshrrev_b32 v46, 3, v1
  v_bfe_u32 v47, v1, 4, 1
  v_lshlrev_b32 v47, 2, v47
  v_xor_b32 v47, v47, v1
  v_and_b32 v47, 7, v47
  v_mul_u32_u24 v46, 896, v46
  v_lshl_add_u32 v46, v47, 4, v46
  s_lshl_b32 s86, s84, 7
  s_mul_i32 s87, s6, 7168
  s_add_u32 s86, s86, s87
  s_lshl_b32 s87, s6, 10
  s_add_u32 m0, s87, 104448
  s_add_u32 s95, s86, 0
  buffer_load_dwordx4 v46, s[80:83], s95 offen lds
  s_add_u32 m0, s87, 112640
  s_add_u32 s95, s86, 57344
  buffer_load_dwordx4 v46, s[80:83], s95 offen lds
  s_add_u32 m0, s87, 120832
  s_add_u32 s95, s86, 114688
  buffer_load_dwordx4 v46, s[80:83], s95 offen lds
  s_add_u32 m0, s87, 129024
  s_add_u32 s95, s86, 172032
  buffer_load_dwordx4 v46, s[80:83], s95 offen lds
  s_add_u32 m0, s87, 137216
  s_add_u32 s95, s86, 229376
  buffer_load_dwordx4 v46, s[80:83], s95 offen lds
  s_add_u32 m0, s87, 145408
  s_add_u32 s95, s86, 286720
  buffer_load_dwordx4 v46, s[80:83], s95 offen lds
  s_add_u32 m0, s87, 153600
  s_add_u32 s95, s86, 344064
  buffer_load_dwordx4 v46, s[80:83], s95 offen lds
LB_nowo:
  v_lshlrev_b32 v46, 3, v1
  v_add_u32 v46, 161792, v46
  ds_write_b64 v46, v[36:37]
  s_lshl_b32 s45, s39, 10
  s_add_u32 s45, s45, s46
  v_lshlrev_b32 v14, 4, v1
  v_add_u32 v14, s45, v14
  ds_read_b128 v[24:27], v14
  ds_read_b64 v[28:29], v14 offset:16
  ds_read_b128 v[40:43], v14 offset:2048
  ds_read_b64 v[44:45], v14 offset:2064
  v_and_b32 v15, 1, v1
  v_lshlrev_b32 v15, 4, v15
  v_add_u32 v15, s46, v15
  ds_write_b128 v15, v[36:39] offset:8256
  ds_write_b128 v15, v[36:39] offset:12416
  ds_write_b128 v15, v[36:39] offset:16576
  s_waitcnt lgkmcnt(5)
  v_alignbit_b32 v48, v25, v24, 16
  v_alignbit_b32 v49, v26, v25, 16
  v_alignbit_b32 v50, v27, v26, 16
  v_alignbit_b32 v51, v28, v27, 16
  v_alignbit_b32 v52, v26, v25, 16
  v_alignbit_b32 v53, v27, v26, 16
  v_alignbit_b32 v54, v28, v27, 16
  v_alignbit_b32 v55, v29, v28, 16
  v_mov_b32 v56, v25
  v_mov_b32 v57, v26
  v_mov_b32 v58, v27
  v_mov_b32 v59, v28
  ds_write_b128 v14, v[48:51] offset:4160
  ds_write_b128 v14, v[56:59] offset:8320
  ds_write_b128 v14, v[52:55] offset:12480
  s_nop 1
  s_waitcnt lgkmcnt(3)
  v_alignbit_b32 v48, v41, v40, 16
  v_alignbit_b32 v49, v42, v41, 16
  v_alignbit_b32 v50, v43, v42, 16
  v_alignbit_b32 v51, v44, v43, 16
  v_alignbit_b32 v52, v42, v41, 16
  v_alignbit_b32 v53, v43, v42, 16
  v_alignbit_b32 v54, v44, v43, 16
  v_alignbit_b32 v55, v45, v44, 16
  v_mov_b32 v56, v41
  v_mov_b32 v57, v42
  v_mov_b32 v58, v43
  v_mov_b32 v59, v44
  ds_write_b128 v14, v[48:51] offset:6208
  ds_write_b128 v14, v[56:59] offset:10368
  ds_write_b128 v14, v[52:55] offset:14528
  s_nop 1
  v_and_b32 v2, 15, v1
  v_lshrrev_b32 v3, 4, v1
  v_and_b32 v4, 3, v2
  v_sub_u32 v4, 3, v4
  v_mul_u32_u24 v4, 4160, v4
  v_lshrrev_b32 v5, 2, v2
  v_lshlrev_b32 v5, 3, v5
  v_lshlrev_b32 v6, 4, v3
  v_sub_u32 v6, v6, v5
  v_add_u32 v6, 24, v6
  v_add3_u32 v4, v4, v6, s46
  s_mul_i32 s45, s38, 4608
  v_lshlrev_b32 v5, 5, v2
  v_lshl_add_u32 v5, v3, 4, v5
  v_add_u32 v5, 69664, v5
  v_add_u32 v5, s45, v5
  v_lshlrev_b32 v6, 5, v2
  v_lshl_add_u32 v6, v3, 3, v6
  s_lshl_b32 s45, s7, 12
  s_add_u32 s45, s45, 2097152
  s_waitcnt lgkmcnt(0)
  s_barrier
  v_mov_b32 v15, 0
  global_load_dword v15, v15, s[32:33] sc1
  s_cmp_eq_u32 s39, 1
  s_cbranch_scc1 LB_convB
  v_mov_b32 v16, 0
  v_mov_b32 v17, 0
  v_mov_b32 v18, 0
  v_mov_b32 v19, 0
  v_mov_b32 v20, 0
  v_mov_b32 v21, 0
  v_mov_b32 v22, 0
  v_mov_b32 v23, 0
  v_mov_b32 v24, 0
  v_mov_b32 v25, 0
  v_mov_b32 v26, 0
  v_mov_b32 v27, 0
  ds_read_b64 v[104:105], v4 offset:4032
  ds_read_b64 v[106:107], v4 offset:4040
  ds_read_b128 v[68:71], v5 offset:4032
  ds_read_b128 v[64:67], v5 offset:3520
  ds_read_b128 v[48:51], v5 offset:1472
  ds_read_b64 v[108:109], v4 offset:3520
  ds_read_b64 v[110:111], v4 offset:3528
  ds_read_b128 v[60:63], v5 offset:3008
  ds_read_b128 v[44:47], v5 offset:960
  ds_read_b64 v[112:113], v4 offset:3008
  ds_read_b64 v[114:115], v4 offset:3016
  ds_read_b128 v[56:59], v5 offset:2496
  s_waitcnt lgkmcnt(9)
  v_mfma_f32_16x16x32_bf16 v[16:19], v[104:107], v[68:71], v[16:19]
  ds_read_b128 v[40:43], v5 offset:448
  ds_read_b64 v[116:117], v4 offset:2496
  ds_read_b64 v[118:119], v4 offset:2504
  s_waitcnt lgkmcnt(11)
  v_mfma_f32_16x16x32_bf16 v[20:23], v[104:107], v[64:67], v[20:23]
  ds_read_b128 v[52:55], v5 offset:1984
  s_waitcnt lgkmcnt(11)
  v_mfma_f32_16x16x32_bf16 v[24:27], v[104:107], v[48:51], v[24:27]
  s_waitcnt lgkmcnt(9)
  v_mfma_f32_16x16x32_bf16 v[16:19], v[108:111], v[64:67], v[16:19]
  ds_read_b64 v[120:121], v4 offset:1984
  ds_read_b64 v[122:123], v4 offset:1992
  s_waitcnt lgkmcnt(10)
  v_mfma_f32_16x16x32_bf16 v[20:23], v[108:111], v[60:63], v[20:23]
  ds_read_b64 v[124:125], v4 offset:1472
  ds_read_b64 v[126:127], v4 offset:1480
  s_waitcnt lgkmcnt(11)
  v_mfma_f32_16x16x32_bf16 v[24:27], v[108:111], v[44:47], v[24:27]
  s_waitcnt lgkmcnt(9)
  v_mfma_f32_16x16x32_bf16 v[16:19], v[112:115], v[60:63], v[16:19]
  ds_read_b64 v[104:105], v4 offset:960
  ds_read_b64 v[106:107], v4 offset:968
  s_waitcnt lgkmcnt(10)
  v_mfma_f32_16x16x32_bf16 v[20:23], v[112:115], v[56:59], v[20:23]
  ds_read_b64 v[108:109], v4 offset:448
  ds_read_b64 v[110:111], v4 offset:456
  s_waitcnt lgkmcnt(11)
  v_mfma_f32_16x16x32_bf16 v[24:27], v[112:115], v[40:43], v[24:27]
  s_waitcnt lgkmcnt(9)
  v_mfma_f32_16x16x32_bf16 v[16:19], v[116:119], v[56:59], v[16:19]
  ds_read_b64 v[112:113], v4 offset:3968
  ds_read_b64 v[114:115], v4 offset:3976
  ds_read_b128 v[100:103], v5 offset:3968
  s_waitcnt lgkmcnt(11)
  v_mfma_f32_16x16x32_bf16 v[20:23], v[116:119], v[52:55], v[20:23]
  ds_read_b128 v[96:99], v5 offset:3456
  s_waitcnt lgkmcnt(10)
  v_mfma_f32_16x16x32_bf16 v[16:19], v[120:123], v[52:55], v[16:19]
  ds_read_b128 v[80:83], v5 offset:1408
  v_mfma_f32_16x16x32_bf16 v[20:23], v[120:123], v[48:51], v[20:23]
  s_waitcnt lgkmcnt(9)
  v_mfma_f32_16x16x32_bf16 v[16:19], v[124:127], v[48:51], v[16:19]
  ds_read_b64 v[116:117], v4 offset:3456
  ds_read_b64 v[118:119], v4 offset:3464
  ds_read_b128 v[92:95], v5 offset:2944
  v_mfma_f32_16x16x32_bf16 v[20:23], v[124:127], v[44:47], v[20:23]
  s_waitcnt lgkmcnt(10)
  v_mfma_f32_16x16x32_bf16 v[16:19], v[104:107], v[44:47], v[16:19]
  ds_read_b128 v[76:79], v5 offset:896
  v_mfma_f32_16x16x32_bf16 v[20:23], v[104:107], v[40:43], v[20:23]
  s_waitcnt lgkmcnt(9)
  v_mfma_f32_16x16x32_bf16 v[16:19], v[108:111], v[40:43], v[16:19]
  ds_read_b64 v[120:121], v4 offset:2944
  ds_read_b64 v[122:123], v4 offset:2952
  ds_read_b128 v[88:91], v5 offset:2432
  s_waitcnt lgkmcnt(9)
  v_mfma_f32_16x16x32_bf16 v[16:19], v[112:115], v[100:103], v[16:19]
  ds_read_b128 v[72:75], v5 offset:384
  ds_read_b64 v[124:125], v4 offset:2432
  ds_read_b64 v[126:127], v4 offset:2440
  s_waitcnt lgkmcnt(11)
  v_mfma_f32_16x16x32_bf16 v[20:23], v[112:115], v[96:99], v[20:23]
  ds_read_b128 v[84:87], v5 offset:1920
  s_waitcnt lgkmcnt(11)
  v_mfma_f32_16x16x32_bf16 v[24:27], v[112:115], v[80:83], v[24:27]
  s_waitcnt lgkmcnt(9)
  v_mfma_f32_16x16x32_bf16 v[16:19], v[116:119], v[96:99], v[16:19]
  ds_read_b64 v[104:105], v4 offset:1920
  ds_read_b64 v[106:107], v4 offset:1928
  s_waitcnt lgkmcnt(10)
  v_mfma_f32_16x16x32_bf16 v[20:23], v[116:119], v[92:95], v[20:23]
  ds_read_b64 v[108:109], v4 offset:1408
  ds_read_b64 v[110:111], v4 offset:1416
  s_waitcnt lgkmcnt(11)
  v_mfma_f32_16x16x32_bf16 v[24:27], v[116:119], v[76:79], v[24:27]
  s_waitcnt lgkmcnt(9)
  v_mfma_f32_16x16x32_bf16 v[16:19], v[120:123], v[92:95], v[16:19]
  ds_read_b64 v[112:113], v4 offset:896
  ds_read_b64 v[114:115], v4 offset:904
  s_waitcnt lgkmcnt(10)
  v_mfma_f32_16x16x32_bf16 v[20:23], v[120:123], v[88:91], v[20:23]
  ds_read_b64 v[116:117], v4 offset:384
  ds_read_b64 v[118:119], v4 offset:392
  s_waitcnt lgkmcnt(11)
  v_mfma_f32_16x16x32_bf16 v[24:27], v[120:123], v[72:75], v[24:27]
  s_waitcnt lgkmcnt(9)
  v_mfma_f32_16x16x32_bf16 v[16:19], v[124:127], v[88:91], v[16:19]
  ds_read_b64 v[120:121], v4 offset:3904
  ds_read_b64 v[122:123], v4 offset:3912
  ds_read_b128 v[68:71], v5 offset:3904
  s_waitcnt lgkmcnt(11)
  v_mfma_f32_16x16x32_bf16 v[20:23], v[124:127], v[84:87], v[20:23]
  ds_read_b128 v[64:67], v5 offset:3392
  s_waitcnt lgkmcnt(10)
  v_mfma_f32_16x16x32_bf16 v[16:19], v[104:107], v[84:87], v[16:19]
  ds_read_b128 v[48:51], v5 offset:1344
  v_mfma_f32_16x16x32_bf16 v[20:23], v[104:107], v[80:83], v[20:23]
  s_waitcnt lgkmcnt(9)
  v_mfma_f32_16x16x32_bf16 v[16:19], v[108:111], v[80:83], v[16:19]
  ds_read_b64 v[124:125], v4 offset:3392
  ds_read_b64 v[126:127], v4 offset:3400
  ds_read_b128 v[60:63], v5 offset:2880
  v_mfma_f32_16x16x32_bf16 v[20:23], v[108:111], v[76:79], v[20:23]
  s_waitcnt lgkmcnt(10)
  v_mfma_f32_16x16x32_bf16 v[16:19], v[112:115], v[76:79], v[16:19]
  ds_read_b128 v[44:47], v5 offset:832
  v_mfma_f32_16x16x32_bf16 v[20:23], v[112:115], v[72:75], v[20:23]
  s_waitcnt lgkmcnt(9)
  v_mfma_f32_16x16x32_bf16 v[16:19], v[116:119], v[72:75], v[16:19]
  ds_read_b64 v[104:105], v4 offset:2880
  ds_read_b64 v[106:107], v4 offset:2888
  ds_read_b128 v[56:59], v5 offset:2368
  s_waitcnt lgkmcnt(9)
  v_mfma_f32_16x16x32_bf16 v[16:19], v[120:123], v[68:71], v[16:19]
  ds_read_b128 v[40:43], v5 offset:320
  ds_read_b64 v[108:109], v4 offset:2368
  ds_read_b64 v[110:111], v4 offset:2376
  s_waitcnt lgkmcnt(11)
  v_mfma_f32_16x16x32_bf16 v[20:23], v[120:123], v[64:67], v[20:23]
  ds_read_b128 v[52:55], v5 offset:1856
  s_waitcnt lgkmcnt(11)
  v_mfma_f32_16x16x32_bf16 v[24:27], v[120:123], v[48:51], v[24:27]
  s_waitcnt lgkmcnt(9)
  v_mfma_f32_16x16x32_bf16 v[16:19], v[124:127], v[64:67], v[16:19]
  ds_read_b64 v[112:113], v4 offset:1856
  ds_read_b64 v[114:115], v4 offset:1864
  s_waitcnt lgkmcnt(10)
  v_mfma_f32_16x16x32_bf16 v[20:23], v[124:127], v[60:63], v[20:23]
  ds_read_b64 v[116:117], v4 offset:1344
  ds_read_b64 v[118:119], v4 offset:1352
  s_waitcnt lgkmcnt(11)
  v_mfma_f32_16x16x32_bf16 v[24:27], v[124:127], v[44:47], v[24:27]
  s_waitcnt lgkmcnt(9)
  v_mfma_f32_16x16x32_bf16 v[16:19], v[104:107], v[60:63], v[16:19]
  ds_read_b64 v[120:121], v4 offset:832
  ds_read_b64 v[122:123], v4 offset:840
  s_waitcnt lgkmcnt(10)
  v_mfma_f32_16x16x32_bf16 v[20:23], v[104:107], v[56:59], v[20:23]
  ds_read_b64 v[124:125], v4 offset:320
  ds_read_b64 v[126:127], v4 offset:328
  s_waitcnt lgkmcnt(11)
  v_mfma_f32_16x16x32_bf16 v[24:27], v[104:107], v[40:43], v[24:27]
  s_waitcnt lgkmcnt(9)
  v_mfma_f32_16x16x32_bf16 v[16:19], v[108:111], v[56:59], v[16:19]
  ds_read_b64 v[104:105], v4 offset:3840
  ds_read_b64 v[106:107], v4 offset:3848
  ds_read_b128 v[100:103], v5 offset:3840
  s_waitcnt lgkmcnt(11)
  v_mfma_f32_16x16x32_bf16 v[20:23], v[108:111], v[52:55], v[20:23]
  ds_read_b128 v[96:99], v5 offset:3328
  s_waitcnt lgkmcnt(10)
  v_mfma_f32_16x16x32_bf16 v[16:19], v[112:115], v[52:55], v[16:19]
  ds_read_b128 v[80:83], v5 offset:1280
  v_mfma_f32_16x16x32_bf16 v[20:23], v[112:115], v[48:51], v[20:23]
  s_waitcnt lgkmcnt(9)
  v_mfma_f32_16x16x32_bf16 v[16:19], v[116:119], v[48:51], v[16:19]
  ds_read_b64 v[108:109], v4 offset:3328
  ds_read_b64 v[110:111], v4 offset:3336
  ds_read_b128 v[92:95], v5 offset:2816
  v_mfma_f32_16x16x32_bf16 v[20:23], v[116:119], v[44:47], v[20:23]
  s_waitcnt lgkmcnt(10)
  v_mfma_f32_16x16x32_bf16 v[16:19], v[120:123], v[44:47], v[16:19]
  ds_read_b128 v[76:79], v5 offset:768
  v_mfma_f32_16x16x32_bf16 v[20:23], v[120:123], v[40:43], v[20:23]
  s_waitcnt lgkmcnt(9)
  v_mfma_f32_16x16x32_bf16 v[16:19], v[124:127], v[40:43], v[16:19]
  ds_read_b64 v[112:113], v4 offset:2816
  ds_read_b64 v[114:115], v4 offset:2824
  ds_read_b128 v[88:91], v5 offset:2304
  s_waitcnt lgkmcnt(9)
  v_mfma_f32_16x16x32_bf16 v[16:19], v[104:107], v[100:103], v[16:19]
  ds_read_b128 v[72:75], v5 offset:256
  ds_read_b64 v[116:117], v4 offset:2304
  ds_read_b64 v[118:119], v4 offset:2312
  s_waitcnt lgkmcnt(11)
  v_mfma_f32_16x16x32_bf16 v[20:23], v[104:107], v[96:99], v[20:23]
  ds_read_b128 v[84:87], v5 offset:1792
  s_waitcnt lgkmcnt(11)
  v_mfma_f32_16x16x32_bf16 v[24:27], v[104:107], v[80:83], v[24:27]
  s_waitcnt lgkmcnt(9)
  v_mfma_f32_16x16x32_bf16 v[16:19], v[108:111], v[96:99], v[16:19]
  ds_read_b64 v[120:121], v4 offset:1792
  ds_read_b64 v[122:123], v4 offset:1800
  s_waitcnt lgkmcnt(10)
  v_mfma_f32_16x16x32_bf16 v[20:23], v[108:111], v[92:95], v[20:23]
  ds_read_b64 v[124:125], v4 offset:1280
  ds_read_b64 v[126:127], v4 offset:1288
  s_waitcnt lgkmcnt(11)
  v_mfma_f32_16x16x32_bf16 v[24:27], v[108:111], v[76:79], v[24:27]
  s_waitcnt lgkmcnt(9)
  v_mfma_f32_16x16x32_bf16 v[16:19], v[112:115], v[92:95], v[16:19]
  ds_read_b64 v[104:105], v4 offset:768
  ds_read_b64 v[106:107], v4 offset:776
  s_waitcnt lgkmcnt(10)
  v_mfma_f32_16x16x32_bf16 v[20:23], v[112:115], v[88:91], v[20:23]
  ds_read_b64 v[108:109], v4 offset:256
  ds_read_b64 v[110:111], v4 offset:264
  s_waitcnt lgkmcnt(11)
  v_mfma_f32_16x16x32_bf16 v[24:27], v[112:115], v[72:75], v[24:27]
  s_waitcnt lgkmcnt(9)
  v_mfma_f32_16x16x32_bf16 v[16:19], v[116:119], v[88:91], v[16:19]
  ds_read_b64 v[112:113], v4 offset:3776
  ds_read_b64 v[114:115], v4 offset:3784
  ds_read_b128 v[68:71], v5 offset:3776
  s_waitcnt lgkmcnt(11)
  v_mfma_f32_16x16x32_bf16 v[20:23], v[116:119], v[84:87], v[20:23]
  ds_read_b128 v[64:67], v5 offset:3264
  s_waitcnt lgkmcnt(10)
  v_mfma_f32_16x16x32_bf16 v[16:19], v[120:123], v[84:87], v[16:19]
  ds_read_b128 v[48:51], v5 offset:1216
  v_mfma_f32_16x16x32_bf16 v[20:23], v[120:123], v[80:83], v[20:23]
  s_waitcnt lgkmcnt(9)
  v_mfma_f32_16x16x32_bf16 v[16:19], v[124:127], v[80:83], v[16:19]
  ds_read_b64 v[116:117], v4 offset:3264
  ds_read_b64 v[118:119], v4 offset:3272
  ds_read_b128 v[60:63], v5 offset:2752
  v_mfma_f32_16x16x32_bf16 v[20:23], v[124:127], v[76:79], v[20:23]
  s_waitcnt lgkmcnt(10)
  v_mfma_f32_16x16x32_bf16 v[16:19], v[104:107], v[76:79], v[16:19]
  ds_read_b128 v[44:47], v5 offset:704
  v_mfma_f32_16x16x32_bf16 v[20:23], v[104:107], v[72:75], v[20:23]
  s_waitcnt lgkmcnt(9)
  v_mfma_f32_16x16x32_bf16 v[16:19], v[108:111], v[72:75], v[16:19]
  ds_read_b64 v[120:121], v4 offset:2752
  ds_read_b64 v[122:123], v4 offset:2760
  ds_read_b128 v[56:59], v5 offset:2240
  s_waitcnt lgkmcnt(9)
  v_mfma_f32_16x16x32_bf16 v[16:19], v[112:115], v[68:71], v[16:19]
  ds_read_b128 v[40:43], v5 offset:192
  ds_read_b64 v[124:125], v4 offset:2240
  ds_read_b64 v[126:127], v4 offset:2248
  s_waitcnt lgkmcnt(11)
  v_mfma_f32_16x16x32_bf16 v[20:23], v[112:115], v[64:67], v[20:23]
  ds_read_b128 v[52:55], v5 offset:1728
  s_waitcnt lgkmcnt(11)
  v_mfma_f32_16x16x32_bf16 v[24:27], v[112:115], v[48:51], v[24:27]
  s_waitcnt lgkmcnt(9)
  v_mfma_f32_16x16x32_bf16 v[16:19], v[116:119], v[64:67], v[16:19]
  ds_read_b64 v[104:105], v4 offset:1728
  ds_read_b64 v[106:107], v4 offset:1736
  s_waitcnt lgkmcnt(10)
  v_mfma_f32_16x16x32_bf16 v[20:23], v[116:119], v[60:63], v[20:23]
  ds_read_b64 v[108:109], v4 offset:1216
  ds_read_b64 v[110:111], v4 offset:1224
  s_waitcnt lgkmcnt(11)
  v_mfma_f32_16x16x32_bf16 v[24:27], v[116:119], v[44:47], v[24:27]
  s_waitcnt lgkmcnt(9)
  v_mfma_f32_16x16x32_bf16 v[16:19], v[120:123], v[60:63], v[16:19]
  ds_read_b64 v[112:113], v4 offset:704
  ds_read_b64 v[114:115], v4 offset:712
  s_waitcnt lgkmcnt(10)
  v_mfma_f32_16x16x32_bf16 v[20:23], v[120:123], v[56:59], v[20:23]
  ds_read_b64 v[116:117], v4 offset:192
  ds_read_b64 v[118:119], v4 offset:200
  s_waitcnt lgkmcnt(11)
  v_mfma_f32_16x16x32_bf16 v[24:27], v[120:123], v[40:43], v[24:27]
  s_waitcnt lgkmcnt(9)
  v_mfma_f32_16x16x32_bf16 v[16:19], v[124:127], v[56:59], v[16:19]
  ds_read_b64 v[120:121], v4 offset:3712
  ds_read_b64 v[122:123], v4 offset:3720
  ds_read_b128 v[100:103], v5 offset:3712
  s_waitcnt lgkmcnt(11)
  v_mfma_f32_16x16x32_bf16 v[20:23], v[124:127], v[52:55], v[20:23]
  ds_read_b128 v[96:99], v5 offset:3200
  s_waitcnt lgkmcnt(10)
  v_mfma_f32_16x16x32_bf16 v[16:19], v[104:107], v[52:55], v[16:19]
  ds_read_b128 v[80:83], v5 offset:1152
  v_mfma_f32_16x16x32_bf16 v[20:23], v[104:107], v[48:51], v[20:23]
  s_waitcnt lgkmcnt(9)
  v_mfma_f32_16x16x32_bf16 v[16:19], v[108:111], v[48:51], v[16:19]
  ds_read_b64 v[124:125], v4 offset:3200
  ds_read_b64 v[126:127], v4 offset:3208
  ds_read_b128 v[92:95], v5 offset:2688
  v_mfma_f32_16x16x32_bf16 v[20:23], v[108:111], v[44:47], v[20:23]
  s_waitcnt lgkmcnt(10)
  v_mfma_f32_16x16x32_bf16 v[16:19], v[112:115], v[44:47], v[16:19]
  ds_read_b128 v[76:79], v5 offset:640
  v_mfma_f32_16x16x32_bf16 v[20:23], v[112:115], v[40:43], v[20:23]
  s_waitcnt lgkmcnt(9)
  v_mfma_f32_16x16x32_bf16 v[16:19], v[116:119], v[40:43], v[16:19]
  ds_read_b64 v[104:105], v4 offset:2688
  ds_read_b64 v[106:107], v4 offset:2696
  ds_read_b128 v[88:91], v5 offset:2176
  s_waitcnt lgkmcnt(9)
  v_mfma_f32_16x16x32_bf16 v[16:19], v[120:123], v[100:103], v[16:19]
  ds_read_b128 v[72:75], v5 offset:128
  ds_read_b64 v[108:109], v4 offset:2176
  ds_read_b64 v[110:111], v4 offset:2184
  s_waitcnt lgkmcnt(11)
  v_mfma_f32_16x16x32_bf16 v[20:23], v[120:123], v[96:99], v[20:23]
  ds_read_b128 v[84:87], v5 offset:1664
  s_waitcnt lgkmcnt(11)
  v_mfma_f32_16x16x32_bf16 v[24:27], v[120:123], v[80:83], v[24:27]
  s_waitcnt lgkmcnt(9)
  v_mfma_f32_16x16x32_bf16 v[16:19], v[124:127], v[96:99], v[16:19]
  ds_read_b64 v[112:113], v4 offset:1664
  ds_read_b64 v[114:115], v4 offset:1672
  s_waitcnt lgkmcnt(10)
  v_mfma_f32_16x16x32_bf16 v[20:23], v[124:127], v[92:95], v[20:23]
  ds_read_b64 v[116:117], v4 offset:1152
  ds_read_b64 v[118:119], v4 offset:1160
  s_waitcnt lgkmcnt(11)
  v_mfma_f32_16x16x32_bf16 v[24:27], v[124:127], v[76:79], v[24:27]
  s_waitcnt lgkmcnt(9)
  v_mfma_f32_16x16x32_bf16 v[16:19], v[104:107], v[92:95], v[16:19]
  ds_read_b64 v[120:121], v4 offset:640
  ds_read_b64 v[122:123], v4 offset:648
  s_waitcnt lgkmcnt(10)
  v_mfma_f32_16x16x32_bf16 v[20:23], v[104:107], v[88:91], v[20:23]
  ds_read_b64 v[124:125], v4 offset:128
  ds_read_b64 v[126:127], v4 offset:136
  s_waitcnt lgkmcnt(11)
  v_mfma_f32_16x16x32_bf16 v[24:27], v[104:107], v[72:75], v[24:27]
  s_waitcnt lgkmcnt(9)
  v_mfma_f32_16x16x32_bf16 v[16:19], v[108:111], v[88:91], v[16:19]
  ds_read_b64 v[104:105], v4 offset:3648
  ds_read_b64 v[106:107], v4 offset:3656
  ds_read_b128 v[68:71], v5 offset:3648
  s_waitcnt lgkmcnt(11)
  v_mfma_f32_16x16x32_bf16 v[20:23], v[108:111], v[84:87], v[20:23]
  ds_read_b128 v[64:67], v5 offset:3136
  s_waitcnt lgkmcnt(10)
  v_mfma_f32_16x16x32_bf16 v[16:19], v[112:115], v[84:87], v[16:19]
  ds_read_b128 v[48:51], v5 offset:1088
  v_mfma_f32_16x16x32_bf16 v[20:23], v[112:115], v[80:83], v[20:23]
  s_waitcnt lgkmcnt(9)
  v_mfma_f32_16x16x32_bf16 v[16:19], v[116:119], v[80:83], v[16:19]
  ds_read_b64 v[108:109], v4 offset:3136
  ds_read_b64 v[110:111], v4 offset:3144
  ds_read_b128 v[60:63], v5 offset:2624
  v_mfma_f32_16x16x32_bf16 v[20:23], v[116:119], v[76:79], v[20:23]
  s_waitcnt lgkmcnt(10)
  v_mfma_f32_16x16x32_bf16 v[16:19], v[120:123], v[76:79], v[16:19]
  ds_read_b128 v[44:47], v5 offset:576
  v_mfma_f32_16x16x32_bf16 v[20:23], v[120:123], v[72:75], v[20:23]
  s_waitcnt lgkmcnt(9)
  v_mfma_f32_16x16x32_bf16 v[16:19], v[124:127], v[72:75], v[16:19]
  ds_read_b64 v[112:113], v4 offset:2624
  ds_read_b64 v[114:115], v4 offset:2632
  ds_read_b128 v[56:59], v5 offset:2112
  s_waitcnt lgkmcnt(9)
  v_mfma_f32_16x16x32_bf16 v[16:19], v[104:107], v[68:71], v[16:19]
  ds_read_b128 v[40:43], v5 offset:64
  ds_read_b64 v[116:117], v4 offset:2112
  ds_read_b64 v[118:119], v4 offset:2120
  s_waitcnt lgkmcnt(11)
  v_mfma_f32_16x16x32_bf16 v[20:23], v[104:107], v[64:67], v[20:23]
  ds_read_b128 v[52:55], v5 offset:1600
  s_waitcnt lgkmcnt(11)
  v_mfma_f32_16x16x32_bf16 v[24:27], v[104:107], v[48:51], v[24:27]
  s_waitcnt lgkmcnt(9)
  v_mfma_f32_16x16x32_bf16 v[16:19], v[108:111], v[64:67], v[16:19]
  ds_read_b64 v[120:121], v4 offset:1600
  ds_read_b64 v[122:123], v4 offset:1608
  s_waitcnt lgkmcnt(10)
  v_mfma_f32_16x16x32_bf16 v[20:23], v[108:111], v[60:63], v[20:23]
  ds_read_b64 v[124:125], v4 offset:1088
  ds_read_b64 v[126:127], v4 offset:1096
  s_waitcnt lgkmcnt(11)
  v_mfma_f32_16x16x32_bf16 v[24:27], v[108:111], v[44:47], v[24:27]
  s_waitcnt lgkmcnt(9)
  v_mfma_f32_16x16x32_bf16 v[16:19], v[112:115], v[60:63], v[16:19]
  ds_read_b64 v[104:105], v4 offset:576
  ds_read_b64 v[106:107], v4 offset:584
  s_waitcnt lgkmcnt(10)
  v_mfma_f32_16x16x32_bf16 v[20:23], v[112:115], v[56:59], v[20:23]
  ds_read_b64 v[108:109], v4 offset:64
  ds_read_b64 v[110:111], v4 offset:72
  s_waitcnt lgkmcnt(11)
  v_mfma_f32_16x16x32_bf16 v[24:27], v[112:115], v[40:43], v[24:27]
  s_waitcnt lgkmcnt(9)
  v_mfma_f32_16x16x32_bf16 v[16:19], v[116:119], v[56:59], v[16:19]
  ds_read_b64 v[112:113], v4 offset:3584
  ds_read_b64 v[114:115], v4 offset:3592
  ds_read_b128 v[100:103], v5 offset:3584
  s_waitcnt lgkmcnt(11)
  v_mfma_f32_16x16x32_bf16 v[20:23], v[116:119], v[52:55], v[20:23]
  ds_read_b128 v[96:99], v5 offset:3072
  s_waitcnt lgkmcnt(10)
  v_mfma_f32_16x16x32_bf16 v[16:19], v[120:123], v[52:55], v[16:19]
  ds_read_b128 v[80:83], v5 offset:1024
  v_mfma_f32_16x16x32_bf16 v[20:23], v[120:123], v[48:51], v[20:23]
  s_waitcnt lgkmcnt(9)
  v_mfma_f32_16x16x32_bf16 v[16:19], v[124:127], v[48:51], v[16:19]
  ds_read_b64 v[116:117], v4 offset:3072
  ds_read_b64 v[118:119], v4 offset:3080
  ds_read_b128 v[92:95], v5 offset:2560
  v_mfma_f32_16x16x32_bf16 v[20:23], v[124:127], v[44:47], v[20:23]
  s_waitcnt lgkmcnt(10)
  v_mfma_f32_16x16x32_bf16 v[16:19], v[104:107], v[44:47], v[16:19]
  ds_read_b128 v[76:79], v5 offset:512
  v_mfma_f32_16x16x32_bf16 v[20:23], v[104:107], v[40:43], v[20:23]
  s_waitcnt lgkmcnt(9)
  v_mfma_f32_16x16x32_bf16 v[16:19], v[108:111], v[40:43], v[16:19]
  ds_read_b64 v[120:121], v4 offset:2560
  ds_read_b64 v[122:123], v4 offset:2568
  ds_read_b128 v[88:91], v5 offset:2048
  s_waitcnt lgkmcnt(9)
  v_mfma_f32_16x16x32_bf16 v[16:19], v[112:115], v[100:103], v[16:19]
  ds_read_b128 v[72:75], v5 offset:0
  ds_read_b64 v[124:125], v4 offset:2048
  ds_read_b64 v[126:127], v4 offset:2056
  s_waitcnt lgkmcnt(11)
  v_mfma_f32_16x16x32_bf16 v[20:23], v[112:115], v[96:99], v[20:23]
  ds_read_b128 v[84:87], v5 offset:1536
  s_waitcnt lgkmcnt(11)
  v_mfma_f32_16x16x32_bf16 v[24:27], v[112:115], v[80:83], v[24:27]
  s_waitcnt lgkmcnt(9)
  v_mfma_f32_16x16x32_bf16 v[16:19], v[116:119], v[96:99], v[16:19]
  ds_read_b64 v[104:105], v4 offset:1536
  ds_read_b64 v[106:107], v4 offset:1544
  s_waitcnt lgkmcnt(10)
  v_mfma_f32_16x16x32_bf16 v[20:23], v[116:119], v[92:95], v[20:23]
  ds_read_b64 v[108:109], v4 offset:1024
  ds_read_b64 v[110:111], v4 offset:1032
  s_waitcnt lgkmcnt(11)
  v_mfma_f32_16x16x32_bf16 v[24:27], v[116:119], v[76:79], v[24:27]
  s_waitcnt lgkmcnt(9)
  v_mfma_f32_16x16x32_bf16 v[16:19], v[120:123], v[92:95], v[16:19]
  ds_read_b64 v[112:113], v4 offset:512
  ds_read_b64 v[114:115], v4 offset:520
  s_waitcnt lgkmcnt(10)
  v_mfma_f32_16x16x32_bf16 v[20:23], v[120:123], v[88:91], v[20:23]
  ds_read_b64 v[116:117], v4 offset:0
  ds_read_b64 v[118:119], v4 offset:8
  s_waitcnt lgkmcnt(11)
  v_mfma_f32_16x16x32_bf16 v[24:27], v[120:123], v[72:75], v[24:27]
  s_waitcnt lgkmcnt(9)
  v_mfma_f32_16x16x32_bf16 v[16:19], v[124:127], v[88:91], v[16:19]
  s_waitcnt lgkmcnt(8)
  v_mfma_f32_16x16x32_bf16 v[20:23], v[124:127], v[84:87], v[20:23]
  s_waitcnt lgkmcnt(6)
  v_mfma_f32_16x16x32_bf16 v[16:19], v[104:107], v[84:87], v[16:19]
  v_mfma_f32_16x16x32_bf16 v[20:23], v[104:107], v[80:83], v[20:23]
  s_waitcnt lgkmcnt(4)
  v_mfma_f32_16x16x32_bf16 v[16:19], v[108:111], v[80:83], v[16:19]
  v_mfma_f32_16x16x32_bf16 v[20:23], v[108:111], v[76:79], v[20:23]
  s_waitcnt lgkmcnt(2)
  v_mfma_f32_16x16x32_bf16 v[16:19], v[112:115], v[76:79], v[16:19]
  v_mfma_f32_16x16x32_bf16 v[20:23], v[112:115], v[72:75], v[20:23]
  s_waitcnt lgkmcnt(0)
  v_mfma_f32_16x16x32_bf16 v[16:19], v[116:119], v[72:75], v[16:19]
  s_lshl_b32 s46, s38, 12
  s_mul_i32 s47, s39, 1536
  s_add_u32 s46, s46, s47
  s_add_u32 s46, s46, 88064
  v_add_u32 v7, s46, v6
  v_lshlrev_b32 v8, 4, v1
  v_add_u32 v9, s46, v8
  s_nop 0
  v_cvt_pk_bf16_f32 v16, v16, v17
  v_cvt_pk_bf16_f32 v17, v18, v19
  ds_write_b64 v7, v[16:17] offset:0
  v_cvt_pk_bf16_f32 v20, v20, v21
  v_cvt_pk_bf16_f32 v21, v22, v23
  ds_write_b64 v7, v[20:21] offset:512
  v_cvt_pk_bf16_f32 v24, v24, v25
  v_cvt_pk_bf16_f32 v25, v26, v27
  ds_write_b64 v7, v[24:25] offset:1024
  s_waitcnt lgkmcnt(0)
  ds_read_b128 v[40:43], v9 offset:0
  v_and_b32 v10, 31, v1
  v_lshlrev_b32 v10, 4, v10
  v_mov_b32 v11, 3584
  v_mov_b32 v12, 3072
  v_cmp_lt_u32 vcc, 31, v1
  s_nop 1
  v_cndmask_b32 v11, v11, v12, vcc
  v_add_u32 v10, v10, v11
  s_waitcnt lgkmcnt(0)
  buffer_store_dwordx4 v[40:43], v10, s[12:15], s45 offen sc1
  s_nop 1
  s_mov_b64 s[50:51], exec
  s_mov_b32 exec_hi, 0
  ds_read_b128 v[44:47], v9 offset:1024
  s_waitcnt lgkmcnt(0)
  buffer_store_dwordx4 v[44:47], v8, s[12:15], s45 offen offset:1024 sc1
  s_mov_b64 exec, s[50:51]
  s_branch LB_end
LB_convB:
  v_mov_b32 v16, 0
  v_mov_b32 v17, 0
  v_mov_b32 v18, 0
  v_mov_b32 v19, 0
  v_mov_b32 v20, 0
  v_mov_b32 v21, 0
  v_mov_b32 v22, 0
  v_mov_b32 v23, 0
  v_mov_b32 v24, 0
  v_mov_b32 v25, 0
  v_mov_b32 v26, 0
  v_mov_b32 v27, 0
  v_mov_b32 v28, 0
  v_mov_b32 v29, 0
  v_mov_b32 v30, 0
  v_mov_b32 v31, 0
  v_mov_b32 v32, 0
  v_mov_b32 v33, 0
  v_mov_b32 v34, 0
  v_mov_b32 v35, 0
  ds_read_b64 v[104:105], v4 offset:4032
  ds_read_b64 v[106:107], v4 offset:4040
  ds_read_b128 v[60:63], v5 offset:3008
  ds_read_b128 v[56:59], v5 offset:2496
  ds_read_b128 v[52:55], v5 offset:1984
  ds_read_b128 v[44:47], v5 offset:960
  ds_read_b128 v[40:43], v5 offset:448
  ds_read_b64 v[108:109], v4 offset:3520
  ds_read_b64 v[110:111], v4 offset:3528
  ds_read_b128 v[48:51], v5 offset:1472
  ds_read_b64 v[112:113], v4 offset:3008
  ds_read_b64 v[114:115], v4 offset:3016
  s_waitcnt lgkmcnt(9)
  v_mfma_f32_16x16x32_bf16 v[16:19], v[104:107], v[60:63], v[16:19]
  ds_read_b64 v[116:117], v4 offset:2496
  ds_read_b64 v[118:119], v4 offset:2504
  s_waitcnt lgkmcnt(10)
  v_mfma_f32_16x16x32_bf16 v[20:23], v[104:107], v[56:59], v[20:23]
  ds_read_b64 v[120:121], v4 offset:1984
  ds_read_b64 v[122:123], v4 offset:1992
  s_waitcnt lgkmcnt(11)
  v_mfma_f32_16x16x32_bf16 v[24:27], v[104:107], v[52:55], v[24:27]
  s_waitcnt lgkmcnt(10)
  v_mfma_f32_16x16x32_bf16 v[28:31], v[104:107], v[44:47], v[28:31]
  ds_read_b64 v[124:125], v4 offset:1472
  ds_read_b64 v[126:127], v4 offset:1480
  s_waitcnt lgkmcnt(11)
  v_mfma_f32_16x16x32_bf16 v[32:35], v[104:107], v[40:43], v[32:35]
  s_waitcnt lgkmcnt(9)
  v_mfma_f32_16x16x32_bf16 v[16:19], v[108:111], v[56:59], v[16:19]
  ds_read_b64 v[104:105], v4 offset:3968
  ds_read_b64 v[106:107], v4 offset:3976
  ds_read_b128 v[92:95], v5 offset:2944
  v_mfma_f32_16x16x32_bf16 v[20:23], v[108:111], v[52:55], v[20:23]
  s_waitcnt lgkmcnt(11)
  v_mfma_f32_16x16x32_bf16 v[24:27], v[108:111], v[48:51], v[24:27]
  ds_read_b128 v[88:91], v5 offset:2432
  v_mfma_f32_16x16x32_bf16 v[28:31], v[108:111], v[40:43], v[28:31]
  s_waitcnt lgkmcnt(10)
  v_mfma_f32_16x16x32_bf16 v[16:19], v[112:115], v[52:55], v[16:19]
  ds_read_b128 v[84:87], v5 offset:1920
  ds_read_b128 v[76:79], v5 offset:896
  v_mfma_f32_16x16x32_bf16 v[20:23], v[112:115], v[48:51], v[20:23]
  v_mfma_f32_16x16x32_bf16 v[24:27], v[112:115], v[44:47], v[24:27]
  s_waitcnt lgkmcnt(10)
  v_mfma_f32_16x16x32_bf16 v[16:19], v[116:119], v[48:51], v[16:19]
  ds_read_b128 v[72:75], v5 offset:384
  v_mfma_f32_16x16x32_bf16 v[20:23], v[116:119], v[44:47], v[20:23]
  v_mfma_f32_16x16x32_bf16 v[24:27], v[116:119], v[40:43], v[24:27]
  s_waitcnt lgkmcnt(9)
  v_mfma_f32_16x16x32_bf16 v[16:19], v[120:123], v[44:47], v[16:19]
  ds_read_b64 v[108:109], v4 offset:3456
  ds_read_b64 v[110:111], v4 offset:3464
  ds_read_b128 v[80:83], v5 offset:1408
  v_mfma_f32_16x16x32_bf16 v[20:23], v[120:123], v[40:43], v[20:23]
  s_waitcnt lgkmcnt(10)
  v_mfma_f32_16x16x32_bf16 v[16:19], v[124:127], v[40:43], v[16:19]
  ds_read_b64 v[112:113], v4 offset:2944
  ds_read_b64 v[114:115], v4 offset:2952
  s_waitcnt lgkmcnt(9)
  v_mfma_f32_16x16x32_bf16 v[16:19], v[104:107], v[92:95], v[16:19]
  ds_read_b64 v[116:117], v4 offset:2432
  ds_read_b64 v[118:119], v4 offset:2440
  s_waitcnt lgkmcnt(10)
  v_mfma_f32_16x16x32_bf16 v[20:23], v[104:107], v[88:91], v[20:23]
  ds_read_b64 v[120:121], v4 offset:1920
  ds_read_b64 v[122:123], v4 offset:1928
  s_waitcnt lgkmcnt(11)
  v_mfma_f32_16x16x32_bf16 v[24:27], v[104:107], v[84:87], v[24:27]
  s_waitcnt lgkmcnt(10)
  v_mfma_f32_16x16x32_bf16 v[28:31], v[104:107], v[76:79], v[28:31]
  ds_read_b64 v[124:125], v4 offset:1408
  ds_read_b64 v[126:127], v4 offset:1416
  s_waitcnt lgkmcnt(11)
  v_mfma_f32_16x16x32_bf16 v[32:35], v[104:107], v[72:75], v[32:35]
  s_waitcnt lgkmcnt(9)
  v_mfma_f32_16x16x32_bf16 v[16:19], v[108:111], v[88:91], v[16:19]
  ds_read_b64 v[104:105], v4 offset:3904
  ds_read_b64 v[106:107], v4 offset:3912
  ds_read_b128 v[60:63], v5 offset:2880
  v_mfma_f32_16x16x32_bf16 v[20:23], v[108:111], v[84:87], v[20:23]
  s_waitcnt lgkmcnt(11)
  v_mfma_f32_16x16x32_bf16 v[24:27], v[108:111], v[80:83], v[24:27]
  ds_read_b128 v[56:59], v5 offset:2368
  v_mfma_f32_16x16x32_bf16 v[28:31], v[108:111], v[72:75], v[28:31]
  s_waitcnt lgkmcnt(10)
  v_mfma_f32_16x16x32_bf16 v[16:19], v[112:115], v[84:87], v[16:19]
  ds_read_b128 v[52:55], v5 offset:1856
  ds_read_b128 v[44:47], v5 offset:832
  v_mfma_f32_16x16x32_bf16 v[20:23], v[112:115], v[80:83], v[20:23]
  v_mfma_f32_16x16x32_bf16 v[24:27], v[112:115], v[76:79], v[24:27]
  s_waitcnt lgkmcnt(10)
  v_mfma_f32_16x16x32_bf16 v[16:19], v[116:119], v[80:83], v[16:19]
  ds_read_b128 v[40:43], v5 offset:320
  v_mfma_f32_16x16x32_bf16 v[20:23], v[116:119], v[76:79], v[20:23]
  v_mfma_f32_16x16x32_bf16 v[24:27], v[116:119], v[72:75], v[24:27]
  s_waitcnt lgkmcnt(9)
  v_mfma_f32_16x16x32_bf16 v[16:19], v[120:123], v[76:79], v[16:19]
  ds_read_b64 v[108:109], v4 offset:3392
  ds_read_b64 v[110:111], v4 offset:3400
  ds_read_b128 v[48:51], v5 offset:1344
  v_mfma_f32_16x16x32_bf16 v[20:23], v[120:123], v[72:75], v[20:23]
  s_waitcnt lgkmcnt(10)
  v_mfma_f32_16x16x32_bf16 v[16:19], v[124:127], v[72:75], v[16:19]
  ds_read_b64 v[112:113], v4 offset:2880
  ds_read_b64 v[114:115], v4 offset:2888
  s_waitcnt lgkmcnt(9)
  v_mfma_f32_16x16x32_bf16 v[16:19], v[104:107], v[60:63], v[16:19]
  ds_read_b64 v[116:117], v4 offset:2368
  ds_read_b64 v[118:119], v4 offset:2376
  s_waitcnt lgkmcnt(10)
  v_mfma_f32_16x16x32_bf16 v[20:23], v[104:107], v[56:59], v[20:23]
  ds_read_b64 v[120:121], v4 offset:1856
  ds_read_b64 v[122:123], v4 offset:1864
  s_waitcnt lgkmcnt(11)
  v_mfma_f32_16x16x32_bf16 v[24:27], v[104:107], v[52:55], v[24:27]
  s_waitcnt lgkmcnt(10)
  v_mfma_f32_16x16x32_bf16 v[28:31], v[104:107], v[44:47], v[28:31]
  ds_read_b64 v[124:125], v4 offset:1344
  ds_read_b64 v[126:127], v4 offset:1352
  s_waitcnt lgkmcnt(11)
  v_mfma_f32_16x16x32_bf16 v[32:35], v[104:107], v[40:43], v[32:35]
  s_waitcnt lgkmcnt(9)
  v_mfma_f32_16x16x32_bf16 v[16:19], v[108:111], v[56:59], v[16:19]
  ds_read_b64 v[104:105], v4 offset:3840
  ds_read_b64 v[106:107], v4 offset:3848
  ds_read_b128 v[92:95], v5 offset:2816
  v_mfma_f32_16x16x32_bf16 v[20:23], v[108:111], v[52:55], v[20:23]
  s_waitcnt lgkmcnt(11)
  v_mfma_f32_16x16x32_bf16 v[24:27], v[108:111], v[48:51], v[24:27]
  ds_read_b128 v[88:91], v5 offset:2304
  v_mfma_f32_16x16x32_bf16 v[28:31], v[108:111], v[40:43], v[28:31]
  s_waitcnt lgkmcnt(10)
  v_mfma_f32_16x16x32_bf16 v[16:19], v[112:115], v[52:55], v[16:19]
  ds_read_b128 v[84:87], v5 offset:1792
  ds_read_b128 v[76:79], v5 offset:768
  v_mfma_f32_16x16x32_bf16 v[20:23], v[112:115], v[48:51], v[20:23]
  v_mfma_f32_16x16x32_bf16 v[24:27], v[112:115], v[44:47], v[24:27]
  s_waitcnt lgkmcnt(10)
  v_mfma_f32_16x16x32_bf16 v[16:19], v[116:119], v[48:51], v[16:19]
  ds_read_b128 v[72:75], v5 offset:256
  v_mfma_f32_16x16x32_bf16 v[20:23], v[116:119], v[44:47], v[20:23]
  v_mfma_f32_16x16x32_bf16 v[24:27], v[116:119], v[40:43], v[24:27]
  s_waitcnt lgkmcnt(9)
  v_mfma_f32_16x16x32_bf16 v[16:19], v[120:123], v[44:47], v[16:19]
  ds_read_b64 v[108:109], v4 offset:3328
  ds_read_b64 v[110:111], v4 offset:3336
  ds_read_b128 v[80:83], v5 offset:1280
  v_mfma_f32_16x16x32_bf16 v[20:23], v[120:123], v[40:43], v[20:23]
  s_waitcnt lgkmcnt(10)
  v_mfma_f32_16x16x32_bf16 v[16:19], v[124:127], v[40:43], v[16:19]
  ds_read_b64 v[112:113], v4 offset:2816
  ds_read_b64 v[114:115], v4 offset:2824
  s_waitcnt lgkmcnt(9)
  v_mfma_f32_16x16x32_bf16 v[16:19], v[104:107], v[92:95], v[16:19]
  ds_read_b64 v[116:117], v4 offset:2304
  ds_read_b64 v[118:119], v4 offset:2312
  s_waitcnt lgkmcnt(10)
  v_mfma_f32_16x16x32_bf16 v[20:23], v[104:107], v[88:91], v[20:23]
  ds_read_b64 v[120:121], v4 offset:1792
  ds_read_b64 v[122:123], v4 offset:1800
  s_waitcnt lgkmcnt(11)
  v_mfma_f32_16x16x32_bf16 v[24:27], v[104:107], v[84:87], v[24:27]
  s_waitcnt lgkmcnt(10)
  v_mfma_f32_16x16x32_bf16 v[28:31], v[104:107], v[76:79], v[28:31]
  ds_read_b64 v[124:125], v4 offset:1280
  ds_read_b64 v[126:127], v4 offset:1288
  s_waitcnt lgkmcnt(11)
  v_mfma_f32_16x16x32_bf16 v[32:35], v[104:107], v[72:75], v[32:35]
  s_waitcnt lgkmcnt(9)
  v_mfma_f32_16x16x32_bf16 v[16:19], v[108:111], v[88:91], v[16:19]
  ds_read_b64 v[104:105], v4 offset:3776
  ds_read_b64 v[106:107], v4 offset:3784
  ds_read_b128 v[60:63], v5 offset:2752
  v_mfma_f32_16x16x32_bf16 v[20:23], v[108:111], v[84:87], v[20:23]
  s_waitcnt lgkmcnt(11)
  v_mfma_f32_16x16x32_bf16 v[24:27], v[108:111], v[80:83], v[24:27]
  ds_read_b128 v[56:59], v5 offset:2240
  v_mfma_f32_16x16x32_bf16 v[28:31], v[108:111], v[72:75], v[28:31]
  s_waitcnt lgkmcnt(10)
  v_mfma_f32_16x16x32_bf16 v[16:19], v[112:115], v[84:87], v[16:19]
  ds_read_b128 v[52:55], v5 offset:1728
  ds_read_b128 v[44:47], v5 offset:704
  v_mfma_f32_16x16x32_bf16 v[20:23], v[112:115], v[80:83], v[20:23]
  v_mfma_f32_16x16x32_bf16 v[24:27], v[112:115], v[76:79], v[24:27]
  s_waitcnt lgkmcnt(10)
  v_mfma_f32_16x16x32_bf16 v[16:19], v[116:119], v[80:83], v[16:19]
  ds_read_b128 v[40:43], v5 offset:192
  v_mfma_f32_16x16x32_bf16 v[20:23], v[116:119], v[76:79], v[20:23]
  v_mfma_f32_16x16x32_bf16 v[24:27], v[116:119], v[72:75], v[24:27]
  s_waitcnt lgkmcnt(9)
  v_mfma_f32_16x16x32_bf16 v[16:19], v[120:123], v[76:79], v[16:19]
  ds_read_b64 v[108:109], v4 offset:3264
  ds_read_b64 v[110:111], v4 offset:3272
  ds_read_b128 v[48:51], v5 offset:1216
  v_mfma_f32_16x16x32_bf16 v[20:23], v[120:123], v[72:75], v[20:23]
  s_waitcnt lgkmcnt(10)
  v_mfma_f32_16x16x32_bf16 v[16:19], v[124:127], v[72:75], v[16:19]
  ds_read_b64 v[112:113], v4 offset:2752
  ds_read_b64 v[114:115], v4 offset:2760
  s_waitcnt lgkmcnt(9)
  v_mfma_f32_16x16x32_bf16 v[16:19], v[104:107], v[60:63], v[16:19]
  ds_read_b64 v[116:117], v4 offset:2240
  ds_read_b64 v[118:119], v4 offset:2248
  s_waitcnt lgkmcnt(10)
  v_mfma_f32_16x16x32_bf16 v[20:23], v[104:107], v[56:59], v[20:23]
  ds_read_b64 v[120:121], v4 offset:1728
  ds_read_b64 v[122:123], v4 offset:1736
  s_waitcnt lgkmcnt(11)
  v_mfma_f32_16x16x32_bf16 v[24:27], v[104:107], v[52:55], v[24:27]
  s_waitcnt lgkmcnt(10)
  v_mfma_f32_16x16x32_bf16 v[28:31], v[104:107], v[44:47], v[28:31]
  ds_read_b64 v[124:125], v4 offset:1216
  ds_read_b64 v[126:127], v4 offset:1224
  s_waitcnt lgkmcnt(11)
  v_mfma_f32_16x16x32_bf16 v[32:35], v[104:107], v[40:43], v[32:35]
  s_waitcnt lgkmcnt(9)
  v_mfma_f32_16x16x32_bf16 v[16:19], v[108:111], v[56:59], v[16:19]
  ds_read_b64 v[104:105], v4 offset:3712
  ds_read_b64 v[106:107], v4 offset:3720
  ds_read_b128 v[92:95], v5 offset:2688
  v_mfma_f32_16x16x32_bf16 v[20:23], v[108:111], v[52:55], v[20:23]
  s_waitcnt lgkmcnt(11)
  v_mfma_f32_16x16x32_bf16 v[24:27], v[108:111], v[48:51], v[24:27]
  ds_read_b128 v[88:91], v5 offset:2176
  v_mfma_f32_16x16x32_bf16 v[28:31], v[108:111], v[40:43], v[28:31]
  s_waitcnt lgkmcnt(10)
  v_mfma_f32_16x16x32_bf16 v[16:19], v[112:115], v[52:55], v[16:19]
  ds_read_b128 v[84:87], v5 offset:1664
  ds_read_b128 v[76:79], v5 offset:640
  v_mfma_f32_16x16x32_bf16 v[20:23], v[112:115], v[48:51], v[20:23]
  v_mfma_f32_16x16x32_bf16 v[24:27], v[112:115], v[44:47], v[24:27]
  s_waitcnt lgkmcnt(10)
  v_mfma_f32_16x16x32_bf16 v[16:19], v[116:119], v[48:51], v[16:19]
  ds_read_b128 v[72:75], v5 offset:128
  v_mfma_f32_16x16x32_bf16 v[20:23], v[116:119], v[44:47], v[20:23]
  v_mfma_f32_16x16x32_bf16 v[24:27], v[116:119], v[40:43], v[24:27]
  s_waitcnt lgkmcnt(9)
  v_mfma_f32_16x16x32_bf16 v[16:19], v[120:123], v[44:47], v[16:19]
  ds_read_b64 v[108:109], v4 offset:3200
  ds_read_b64 v[110:111], v4 offset:3208
  ds_read_b128 v[80:83], v5 offset:1152
  v_mfma_f32_16x16x32_bf16 v[20:23], v[120:123], v[40:43], v[20:23]
  s_waitcnt lgkmcnt(10)
  v_mfma_f32_16x16x32_bf16 v[16:19], v[124:127], v[40:43], v[16:19]
  ds_read_b64 v[112:113], v4 offset:2688
  ds_read_b64 v[114:115], v4 offset:2696
  s_waitcnt lgkmcnt(9)
  v_mfma_f32_16x16x32_bf16 v[16:19], v[104:107], v[92:95], v[16:19]
  ds_read_b64 v[116:117], v4 offset:2176
  ds_read_b64 v[118:119], v4 offset:2184
  s_waitcnt lgkmcnt(10)
  v_mfma_f32_16x16x32_bf16 v[20:23], v[104:107], v[88:91], v[20:23]
  ds_read_b64 v[120:121], v4 offset:1664
  ds_read_b64 v[122:123], v4 offset:1672
  s_waitcnt lgkmcnt(11)
  v_mfma_f32_16x16x32_bf16 v[24:27], v[104:107], v[84:87], v[24:27]
  s_waitcnt lgkmcnt(10)
  v_mfma_f32_16x16x32_bf16 v[28:31], v[104:107], v[76:79], v[28:31]
  ds_read_b64 v[124:125], v4 offset:1152
  ds_read_b64 v[126:127], v4 offset:1160
  s_waitcnt lgkmcnt(11)
  v_mfma_f32_16x16x32_bf16 v[32:35], v[104:107], v[72:75], v[32:35]
  s_waitcnt lgkmcnt(9)
  v_mfma_f32_16x16x32_bf16 v[16:19], v[108:111], v[88:91], v[16:19]
  ds_read_b64 v[104:105], v4 offset:3648
  ds_read_b64 v[106:107], v4 offset:3656
  ds_read_b128 v[60:63], v5 offset:2624
  v_mfma_f32_16x16x32_bf16 v[20:23], v[108:111], v[84:87], v[20:23]
  s_waitcnt lgkmcnt(11)
  v_mfma_f32_16x16x32_bf16 v[24:27], v[108:111], v[80:83], v[24:27]
  ds_read_b128 v[56:59], v5 offset:2112
  v_mfma_f32_16x16x32_bf16 v[28:31], v[108:111], v[72:75], v[28:31]
  s_waitcnt lgkmcnt(10)
  v_mfma_f32_16x16x32_bf16 v[16:19], v[112:115], v[84:87], v[16:19]
  ds_read_b128 v[52:55], v5 offset:1600
  ds_read_b128 v[44:47], v5 offset:576
  v_mfma_f32_16x16x32_bf16 v[20:23], v[112:115], v[80:83], v[20:23]
  v_mfma_f32_16x16x32_bf16 v[24:27], v[112:115], v[76:79], v[24:27]
  s_waitcnt lgkmcnt(10)
  v_mfma_f32_16x16x32_bf16 v[16:19], v[116:119], v[80:83], v[16:19]
  ds_read_b128 v[40:43], v5 offset:64
  v_mfma_f32_16x16x32_bf16 v[20:23], v[116:119], v[76:79], v[20:23]
  v_mfma_f32_16x16x32_bf16 v[24:27], v[116:119], v[72:75], v[24:27]
  s_waitcnt lgkmcnt(9)
  v_mfma_f32_16x16x32_bf16 v[16:19], v[120:123], v[76:79], v[16:19]
  ds_read_b64 v[108:109], v4 offset:3136
  ds_read_b64 v[110:111], v4 offset:3144
  ds_read_b128 v[48:51], v5 offset:1088
  v_mfma_f32_16x16x32_bf16 v[20:23], v[120:123], v[72:75], v[20:23]
  s_waitcnt lgkmcnt(10)
  v_mfma_f32_16x16x32_bf16 v[16:19], v[124:127], v[72:75], v[16:19]
  ds_read_b64 v[112:113], v4 offset:2624
  ds_read_b64 v[114:115], v4 offset:2632
  s_waitcnt lgkmcnt(9)
  v_mfma_f32_16x16x32_bf16 v[16:19], v[104:107], v[60:63], v[16:19]
  ds_read_b64 v[116:117], v4 offset:2112
  ds_read_b64 v[118:119], v4 offset:2120
  s_waitcnt lgkmcnt(10)
  v_mfma_f32_16x16x32_bf16 v[20:23], v[104:107], v[56:59], v[20:23]
  ds_read_b64 v[120:121], v4 offset:1600
  ds_read_b64 v[122:123], v4 offset:1608
  s_waitcnt lgkmcnt(11)
  v_mfma_f32_16x16x32_bf16 v[24:27], v[104:107], v[52:55], v[24:27]
  s_waitcnt lgkmcnt(10)
  v_mfma_f32_16x16x32_bf16 v[28:31], v[104:107], v[44:47], v[28:31]
  ds_read_b64 v[124:125], v4 offset:1088
  ds_read_b64 v[126:127], v4 offset:1096
  s_waitcnt lgkmcnt(11)
  v_mfma_f32_16x16x32_bf16 v[32:35], v[104:107], v[40:43], v[32:35]
  s_waitcnt lgkmcnt(9)
  v_mfma_f32_16x16x32_bf16 v[16:19], v[108:111], v[56:59], v[16:19]
  ds_read_b64 v[104:105], v4 offset:3584
  ds_read_b64 v[106:107], v4 offset:3592
  ds_read_b128 v[92:95], v5 offset:2560
  v_mfma_f32_16x16x32_bf16 v[20:23], v[108:111], v[52:55], v[20:23]
  s_waitcnt lgkmcnt(11)
  v_mfma_f32_16x16x32_bf16 v[24:27], v[108:111], v[48:51], v[24:27]
  ds_read_b128 v[88:91], v5 offset:2048
  v_mfma_f32_16x16x32_bf16 v[28:31], v[108:111], v[40:43], v[28:31]
  s_waitcnt lgkmcnt(10)
  v_mfma_f32_16x16x32_bf16 v[16:19], v[112:115], v[52:55], v[16:19]
  ds_read_b128 v[84:87], v5 offset:1536
  ds_read_b128 v[76:79], v5 offset:512
  v_mfma_f32_16x16x32_bf16 v[20:23], v[112:115], v[48:51], v[20:23]
  v_mfma_f32_16x16x32_bf16 v[24:27], v[112:115], v[44:47], v[24:27]
  s_waitcnt lgkmcnt(10)
  v_mfma_f32_16x16x32_bf16 v[16:19], v[116:119], v[48:51], v[16:19]
  ds_read_b128 v[72:75], v5 offset:0
  v_mfma_f32_16x16x32_bf16 v[20:23], v[116:119], v[44:47], v[20:23]
  v_mfma_f32_16x16x32_bf16 v[24:27], v[116:119], v[40:43], v[24:27]
  s_waitcnt lgkmcnt(9)
  v_mfma_f32_16x16x32_bf16 v[16:19], v[120:123], v[44:47], v[16:19]
  ds_read_b64 v[108:109], v4 offset:3072
  ds_read_b64 v[110:111], v4 offset:3080
  ds_read_b128 v[80:83], v5 offset:1024
  v_mfma_f32_16x16x32_bf16 v[20:23], v[120:123], v[40:43], v[20:23]
  s_waitcnt lgkmcnt(10)
  v_mfma_f32_16x16x32_bf16 v[16:19], v[124:127], v[40:43], v[16:19]
  ds_read_b64 v[112:113], v4 offset:2560
  ds_read_b64 v[114:115], v4 offset:2568
  s_waitcnt lgkmcnt(9)
  v_mfma_f32_16x16x32_bf16 v[16:19], v[104:107], v[92:95], v[16:19]
  ds_read_b64 v[116:117], v4 offset:2048
  ds_read_b64 v[118:119], v4 offset:2056
  s_waitcnt lgkmcnt(10)
  v_mfma_f32_16x16x32_bf16 v[20:23], v[104:107], v[88:91], v[20:23]
  ds_read_b64 v[120:121], v4 offset:1536
  ds_read_b64 v[122:123], v4 offset:1544
  s_waitcnt lgkmcnt(11)
  v_mfma_f32_16x16x32_bf16 v[24:27], v[104:107], v[84:87], v[24:27]
  s_waitcnt lgkmcnt(10)
  v_mfma_f32_16x16x32_bf16 v[28:31], v[104:107], v[76:79], v[28:31]
  ds_read_b64 v[124:125], v4 offset:1024
  ds_read_b64 v[126:127], v4 offset:1032
  s_waitcnt lgkmcnt(11)
  v_mfma_f32_16x16x32_bf16 v[32:35], v[104:107], v[72:75], v[32:35]
  s_waitcnt lgkmcnt(9)
  v_mfma_f32_16x16x32_bf16 v[16:19], v[108:111], v[88:91], v[16:19]
  v_mfma_f32_16x16x32_bf16 v[20:23], v[108:111], v[84:87], v[20:23]
  s_waitcnt lgkmcnt(8)
  v_mfma_f32_16x16x32_bf16 v[24:27], v[108:111], v[80:83], v[24:27]
  v_mfma_f32_16x16x32_bf16 v[28:31], v[108:111], v[72:75], v[28:31]
  s_waitcnt lgkmcnt(6)
  v_mfma_f32_16x16x32_bf16 v[16:19], v[112:115], v[84:87], v[16:19]
  v_mfma_f32_16x16x32_bf16 v[20:23], v[112:115], v[80:83], v[20:23]
  v_mfma_f32_16x16x32_bf16 v[24:27], v[112:115], v[76:79], v[24:27]
  s_waitcnt lgkmcnt(4)
  v_mfma_f32_16x16x32_bf16 v[16:19], v[116:119], v[80:83], v[16:19]
  v_mfma_f32_16x16x32_bf16 v[20:23], v[116:119], v[76:79], v[20:23]
  v_mfma_f32_16x16x32_bf16 v[24:27], v[116:119], v[72:75], v[24:27]
  s_waitcnt lgkmcnt(2)
  v_mfma_f32_16x16x32_bf16 v[16:19], v[120:123], v[76:79], v[16:19]
  v_mfma_f32_16x16x32_bf16 v[20:23], v[120:123], v[72:75], v[20:23]
  s_waitcnt lgkmcnt(0)
  v_mfma_f32_16x16x32_bf16 v[16:19], v[124:127], v[72:75], v[16:19]
  s_lshl_b32 s46, s38, 12
  s_mul_i32 s47, s39, 1536
  s_add_u32 s46, s46, s47
  s_add_u32 s46, s46, 88064
  v_add_u32 v7, s46, v6
  v_lshlrev_b32 v8, 4, v1
  v_add_u32 v9, s46, v8
  s_nop 0
  v_cvt_pk_bf16_f32 v16, v16, v17
  v_cvt_pk_bf16_f32 v17, v18, v19
  ds_write_b64 v7, v[16:17] offset:0
  v_cvt_pk_bf16_f32 v20, v20, v21
  v_cvt_pk_bf16_f32 v21, v22, v23
  ds_write_b64 v7, v[20:21] offset:512
  v_cvt_pk_bf16_f32 v24, v24, v25
  v_cvt_pk_bf16_f32 v25, v26, v27
  ds_write_b64 v7, v[24:25] offset:1024
  v_cvt_pk_bf16_f32 v28, v28, v29
  v_cvt_pk_bf16_f32 v29, v30, v31
  ds_write_b64 v7, v[28:29] offset:1536
  v_cvt_pk_bf16_f32 v32, v32, v33
  v_cvt_pk_bf16_f32 v33, v34, v35
  ds_write_b64 v7, v[32:33] offset:2048
  s_waitcnt lgkmcnt(0)
  ds_read_b128 v[40:43], v9 offset:0
  v_and_b32 v10, 31, v1
  v_lshlrev_b32 v10, 4, v10
  v_mov_b32 v11, 2560
  v_mov_b32 v12, 2048
  v_cmp_lt_u32 vcc, 31, v1
  s_nop 1
  v_cndmask_b32 v11, v11, v12, vcc
  v_add_u32 v10, v10, v11
  s_waitcnt lgkmcnt(0)
  buffer_store_dwordx4 v[40:43], v10, s[12:15], s45 offen sc1
  s_nop 1
  ds_read_b128 v[40:43], v9 offset:1024
  v_and_b32 v10, 31, v1
  v_lshlrev_b32 v10, 4, v10
  v_mov_b32 v11, 1536
  v_mov_b32 v12, 512
  v_cmp_lt_u32 vcc, 31, v1
  s_nop 1
  v_cndmask_b32 v11, v11, v12, vcc
  v_add_u32 v10, v10, v11
  s_waitcnt lgkmcnt(0)
  buffer_store_dwordx4 v[40:43], v10, s[12:15], s45 offen sc1
  s_nop 1
  s_mov_b64 s[50:51], exec
  s_mov_b32 exec_hi, 0
  ds_read_b128 v[44:47], v9 offset:2048
  s_waitcnt lgkmcnt(0)
  buffer_store_dwordx4 v[44:47], v8, s[12:15], s45 offen offset:0 sc1
  s_mov_b64 exec, s[50:51]
LB_end:
  s_waitcnt vmcnt(0)
  s_barrier
  s_cmp_lg_u32 s6, 0
  s_cbranch_scc1 LB_nopub2
  v_readfirstlane_b32 s96, v15
  s_nop 0
  s_cmp_lg_u32 s96, 0
  s_cbranch_scc1 LB_tok_ok
  v_mov_b32 v16, 0
  s_mov_b32 s51, 0
LB_tok:
  global_load_dword v2, v16, s[32:33] sc1
  s_waitcnt vmcnt(0)
  v_readfirstlane_b32 s96, v2
  s_nop 0
  s_cmp_lg_u32 s96, 0
  s_cbranch_scc1 LB_tok_ok
  s_sleep 4
  s_add_u32 s51, s51, 1
  s_cmp_lt_u32 s51, 0x20000
  s_cbranch_scc1 LB_tok
LB_tok_ok:
  s_lshr_b32 s51, s3, 4
  s_lshl_b32 s51, s51, 12
  s_and_b32 s54, s3, 15
  s_lshl_b32 s54, s54, 2
  s_add_u32 s51, s51, s54
  s_add_u32 s51, s51, 9437248
  v_and_b32 v27, 3, v1
  v_lshlrev_b32 v27, 10, v27
  v_lshrrev_b32 v16, 2, v1
  v_lshl_add_u32 v27, v16, 7, v27
  v_mov_b32 v2, s96
  s_mov_b64 s[56:57], exec
  s_mov_b32 exec_hi, 0
  buffer_store_dword v2, v27, s[12:15], s51 offen sc1
  s_mov_b64 exec, s[56:57]
LB_nopub2:
  s_cmp_ge_u32 s2, 224
  s_cbranch_scc1 LFB_exit
  s_load_dwordx2 s[36:37], s[0:1], 0
  s_load_dwordx2 s[40:41], s[0:1], 96
  s_load_dwordx2 s[38:39], s[0:1], 112
  v_and_b32 v1, 63, v0
  v_and_b32 v3, 31, v1
  v_lshrrev_b32 v4, 5, v1
  s_and_b32 s43, s6, 1
  s_bfe_u32 s44, s6, 0x10001
  s_lshr_b32 s42, s6, 2
  s_lshl_b32 s45, s85, 6
  s_lshl_b32 s46, s43, 5
  s_add_u32 s46, s45, s46
  v_add_u32 v5, s46, v3
  v_mul_u32_u24 v6, 896, v5
  v_lshrrev_b32 v8, 3, v1
  v_and_b32 v9, 7, v1
  v_lshrrev_b32 v10, 4, v1
  v_xor_b32 v10, v10, v1
  v_and_b32 v10, 3, v10
  v_lshrrev_b32 v11, 2, v1
  v_lshlrev_b32 v11, 6, v11
  v_lshl_add_u32 v11, v10, 4, v11
  v_bfe_u32 v10, v8, 1, 1
  v_lshlrev_b32 v10, 2, v10
  v_xor_b32 v10, v10, v9
  v_lshlrev_b32 v12, 12, v8
  v_lshl_add_u32 v12, v10, 4, v12
  s_waitcnt lgkmcnt(0)
  s_mov_b32 s8, s36
  s_mov_b32 s9, s37
  s_mov_b32 s10, 1835008
  s_mov_b32 s11, 0x00020000
  s_mov_b32 s20, s38
  s_mov_b32 s21, s39
  s_mov_b32 s22, 1835008
  s_mov_b32 s23, 0x00020000
  s_lshl_b32 s49, s84, 7
  s_lshl_b32 s51, s44, 6
  s_add_u32 s49, s49, s51
  s_lshl_b32 s51, s42, 5
  s_add_u32 s49, s49, s51
  v_lshl_add_u32 v13, v4, 3, v6
  v_lshlrev_b32 v14, 3, v4
  v_add_u32 v14, s49, v14
  v_lshlrev_b32 v15, 2, v5
  buffer_load_dwordx2 v[144:145], v13, s[8:11], s49 offen offset:0
  buffer_load_dwordx2 v[146:147], v13, s[8:11], s49 offen offset:16
  global_load_dwordx2 v[148:149], v14, s[40:41] offset:0
  global_load_dwordx2 v[150:151], v14, s[40:41] offset:16
  s_cmp_lg_u32 s6, 0
  s_cbranch_scc1 LFB_nopoll
  s_lshl_b32 s47, s2, 7
  s_add_u32 s47, s47, 9437184
  v_lshlrev_b32 v16, 2, v1
  v_add_u32 v16, s47, v16
  s_mov_b32 s51, 0
  s_mov_b64 s[56:57], exec
  s_mov_b64 exec, 0xffffffff
LFB_poll:
  buffer_load_dword v18, v16, s[12:15], 0 offen sc1
  s_waitcnt vmcnt(0)
  v_cmp_ne_u32 vcc, s96, v18
  s_cbranch_vccz LFB_poll_ok
  s_sleep 4
  s_add_u32 s51, s51, 1
  s_cmp_lt_u32 s51, 0x20000
  s_cbranch_scc1 LFB_poll
LFB_poll_ok:
  s_mov_b64 exec, s[56:57]
LFB_nopoll:
  s_barrier
  s_lshl_b32 s47, s6, 18
  s_lshl_b32 s51, s45, 6
  s_add_u32 s47, s47, s51
  s_add_u32 s47, s47, 6291456
  s_lshl_b32 s48, s6, 13
  s_add_u32 m0, s48, 0
  s_add_u32 s51, s47, 0
  buffer_load_dwordx4 v11, s[12:15], s51 offen sc1 lds
  s_add_u32 m0, s48, 1024
  s_add_u32 s51, s47, 1024
  buffer_load_dwordx4 v11, s[12:15], s51 offen sc1 lds
  s_add_u32 m0, s48, 2048
  s_add_u32 s51, s47, 2048
  buffer_load_dwordx4 v11, s[12:15], s51 offen sc1 lds
  s_add_u32 m0, s48, 3072
  s_add_u32 s51, s47, 3072
  buffer_load_dwordx4 v11, s[12:15], s51 offen sc1 lds
  s_add_u32 m0, s48, 4096
  s_add_u32 s51, s47, 131072
  buffer_load_dwordx4 v11, s[12:15], s51 offen sc1 lds
  s_add_u32 m0, s48, 5120
  s_add_u32 s51, s47, 132096
  buffer_load_dwordx4 v11, s[12:15], s51 offen sc1 lds
  s_add_u32 m0, s48, 6144
  s_add_u32 s51, s47, 133120
  buffer_load_dwordx4 v11, s[12:15], s51 offen sc1 lds
  s_add_u32 m0, s48, 7168
  s_add_u32 s51, s47, 134144
  buffer_load_dwordx4 v11, s[12:15], s51 offen sc1 lds
  s_lshl_b32 s48, s6, 10
  s_lshl_b32 s47, s84, 18
  s_lshl_b32 s51, s85, 7
  s_add_u32 s47, s47, s51
  s_lshl_b32 s51, s6, 15
  s_add_u32 s47, s47, s51
  s_add_u32 s47, s47, 2097152
  s_add_u32 m0, s48, 65536
  s_mov_b32 s51, 8388608
  buffer_load_dwordx4 v12, s[12:15], s47 offen sc1 lds
  buffer_load_dword v152, v15, s[12:15], s51 offen sc1
  v_and_b32 v2, 15, v1
  v_lshrrev_b32 v8, 4, v1
  v_lshrrev_b32 v9, 1, v8
  v_lshlrev_b32 v9, 3, v9
  v_lshrrev_b32 v10, 2, v2
  v_add_u32 v9, v9, v10
  v_lshlrev_b32 v9, 7, v9
  v_and_b32 v8, 1, v8
  v_lshl_add_u32 v9, v8, 5, v9
  v_and_b32 v10, 3, v2
  v_lshl_add_u32 v9, v10, 3, v9
  v_bfe_u32 v10, v2, 3, 1
  v_xor_b32 v10, s44, v10
  v_lshl_add_u32 v9, v10, 6, v9
  s_mul_i32 s51, s42, 28672
  s_add_u32 s51, s51, 104448
  v_add_u32 v9, s51, v9
  v_lshrrev_b32 v8, 4, v1
  v_lshrrev_b32 v10, 1, v8
  v_lshlrev_b32 v10, 2, v10
  v_lshrrev_b32 v12, 2, v2
  v_add_u32 v10, v10, v12
  s_lshl_b32 s51, s44, 5
  s_lshl_b32 s47, s42, 4
  s_add_u32 s51, s51, s47
  v_add_u32 v10, s51, v10
  v_lshlrev_b32 v10, 7, v10
  v_and_b32 v8, 1, v8
  v_lshl_add_u32 v10, v8, 5, v10
  v_and_b32 v12, 3, v2
  v_lshl_add_u32 v10, v12, 3, v10
  v_bfe_u32 v12, v2, 3, 1
  v_xor_b32 v12, s43, v12
  v_lshl_add_u32 v10, v12, 6, v10
  v_add_u32 v10, 65536, v10
  v_bfe_u32 v2, v3, 2, 2
  s_lshl_b32 s51, s43, 11
  s_lshl_b32 s47, s42, 15
  s_add_u32 s51, s51, s47
  s_add_u32 s51, s51, 0
  v_lshlrev_b32 v12, 6, v3
  v_add_u32 v12, s51, v12
  v_add_u32 v20, 0, v4
  v_xor_b32 v20, v20, v2
  v_lshl_add_u32 v20, v20, 4, v12
  v_add_u32 v21, 2, v4
  v_xor_b32 v21, v21, v2
  v_lshl_add_u32 v21, v21, 4, v12
  v_lshlrev_b32 v2, 4, v1
  s_lshl_b32 s51, s6, 11
  s_add_u32 s51, s51, 73728
  v_add_u32 v22, s51, v2
  s_xor_b32 s51, s6, 4
  s_lshl_b32 s51, s51, 11
  s_add_u32 s51, s51, 73728
  v_add_u32 v23, s51, v2
  v_mov_b32 v128, 0
  v_mov_b32 v129, 0
  v_mov_b32 v130, 0
  v_mov_b32 v131, 0
  v_mov_b32 v132, 0
  v_mov_b32 v133, 0
  v_mov_b32 v134, 0
  v_mov_b32 v135, 0
  v_mov_b32 v136, 0
  v_mov_b32 v137, 0
  v_mov_b32 v138, 0
  v_mov_b32 v139, 0
  v_mov_b32 v140, 0
  v_mov_b32 v141, 0
  v_mov_b32 v142, 0
  v_mov_b32 v143, 0
  s_waitcnt vmcnt(0)
  s_barrier
  ds_read_b64_tr_b16 v[176:177], v9 offset:0
  ds_read_b64_tr_b16 v[178:179], v9 offset:512
  ds_read_b128 v[192:195], v20 offset:0
  ds_read_b64_tr_b16 v[180:181], v9 offset:2048
  ds_read_b64_tr_b16 v[182:183], v9 offset:2560
  ds_read_b128 v[196:199], v21 offset:0
  ds_read_b64_tr_b16 v[184:185], v9 offset:3584
  ds_read_b64_tr_b16 v[186:187], v9 offset:4096
  ds_read_b128 v[200:203], v20 offset:4096
  ds_read_b64_tr_b16 v[188:189], v9 offset:5632
  ds_read_b64_tr_b16 v[190:191], v9 offset:6144
  ds_read_b128 v[204:207], v21 offset:4096
  s_waitcnt lgkmcnt(0)
  v_mfma_f32_32x32x16_bf16 v[128:143], v[176:179], v[192:195], v[128:143]
  ds_read_b64_tr_b16 v[208:209], v9 offset:7168
  ds_read_b64_tr_b16 v[210:211], v9 offset:7680
  ds_read_b128 v[224:227], v20 offset:8192
  v_mfma_f32_32x32x16_bf16 v[128:143], v[180:183], v[196:199], v[128:143]
  ds_read_b64_tr_b16 v[212:213], v9 offset:9216
  ds_read_b64_tr_b16 v[214:215], v9 offset:9728
  ds_read_b128 v[228:231], v21 offset:8192
  v_mfma_f32_32x32x16_bf16 v[128:143], v[184:187], v[200:203], v[128:143]
  ds_read_b64_tr_b16 v[216:217], v9 offset:10752
  ds_read_b64_tr_b16 v[218:219], v9 offset:11264
  ds_read_b128 v[232:235], v20 offset:12288
  v_mfma_f32_32x32x16_bf16 v[128:143], v[188:191], v[204:207], v[128:143]
  ds_read_b64_tr_b16 v[220:221], v9 offset:12800
  ds_read_b64_tr_b16 v[222:223], v9 offset:13312
  ds_read_b128 v[236:239], v21 offset:12288
  s_waitcnt lgkmcnt(0)
  v_mfma_f32_32x32x16_bf16 v[128:143], v[208:211], v[224:227], v[128:143]
  ds_read_b64_tr_b16 v[176:177], v9 offset:14336
  ds_read_b64_tr_b16 v[178:179], v9 offset:14848
  ds_read_b128 v[192:195], v20 offset:16384
  v_mfma_f32_32x32x16_bf16 v[128:143], v[212:215], v[228:231], v[128:143]
  ds_read_b64_tr_b16 v[180:181], v9 offset:16384
  ds_read_b64_tr_b16 v[182:183], v9 offset:16896
  ds_read_b128 v[196:199], v21 offset:16384
  v_mfma_f32_32x32x16_bf16 v[128:143], v[216:219], v[232:235], v[128:143]
  ds_read_b64_tr_b16 v[184:185], v9 offset:17920
  ds_read_b64_tr_b16 v[186:187], v9 offset:18432
  ds_read_b128 v[200:203], v20 offset:20480
  v_mfma_f32_32x32x16_bf16 v[128:143], v[220:223], v[236:239], v[128:143]
  ds_read_b64_tr_b16 v[188:189], v9 offset:19968
  ds_read_b64_tr_b16 v[190:191], v9 offset:20480
  ds_read_b128 v[204:207], v21 offset:20480
  s_waitcnt lgkmcnt(0)
  v_mfma_f32_32x32x16_bf16 v[128:143], v[176:179], v[192:195], v[128:143]
  ds_read_b64_tr_b16 v[208:209], v9 offset:21504
  ds_read_b64_tr_b16 v[210:211], v9 offset:22016
  ds_read_b128 v[224:227], v20 offset:24576
  v_mfma_f32_32x32x16_bf16 v[128:143], v[180:183], v[196:199], v[128:143]
  ds_read_b64_tr_b16 v[212:213], v9 offset:23552
  ds_read_b64_tr_b16 v[214:215], v9 offset:24064
  ds_read_b128 v[228:231], v21 offset:24576
  v_mfma_f32_32x32x16_bf16 v[128:143], v[184:187], v[200:203], v[128:143]
  ds_read_b64_tr_b16 v[216:217], v9 offset:25088
  ds_read_b64_tr_b16 v[218:219], v9 offset:25600
  ds_read_b128 v[232:235], v20 offset:28672
  v_mfma_f32_32x32x16_bf16 v[128:143], v[188:191], v[204:207], v[128:143]
  ds_read_b64_tr_b16 v[220:221], v9 offset:27136
  ds_read_b64_tr_b16 v[222:223], v9 offset:27648
  ds_read_b128 v[236:239], v21 offset:28672
  s_waitcnt lgkmcnt(0)
  v_mfma_f32_32x32x16_bf16 v[128:143], v[208:211], v[224:227], v[128:143]
  ds_read_b64_tr_b16 v[154:155], v10 offset:0
  v_mfma_f32_32x32x16_bf16 v[128:143], v[212:215], v[228:231], v[128:143]
  v_mfma_f32_32x32x16_bf16 v[128:143], v[216:219], v[232:235], v[128:143]
  ds_read_b64_tr_b16 v[156:157], v10 offset:1024
  v_mfma_f32_32x32x16_bf16 v[128:143], v[220:223], v[236:239], v[128:143]
  s_cmp_eq_u32 s42, 0
  s_cbranch_scc1 LFB_noswap
  s_nop 9
  v_swap_b32 v128, v136
  v_swap_b32 v129, v137
  v_swap_b32 v130, v138
  v_swap_b32 v131, v139
  v_swap_b32 v132, v140
  v_swap_b32 v133, v141
  v_swap_b32 v134, v142
  v_swap_b32 v135, v143
LFB_noswap:
  s_nop 7
  s_nop 7
  ds_write_b128 v22, v[136:139]
  ds_write_b128 v22, v[140:143] offset:1024
  v_sub_f32 v153, 1.0, v152
  v_cvt_pk_bf16_f32 v153, v153, v153
  v_lshlrev_b32 v153, 16, v153
  s_waitcnt lgkmcnt(0)
  s_barrier
  ds_read_b128 v[136:139], v23
  ds_read_b128 v[140:143], v23 offset:1024
  s_waitcnt lgkmcnt(0)
  v_pk_add_f32 v[128:129], v[128:129], v[136:137]
  v_pk_add_f32 v[130:131], v[130:131], v[138:139]
  v_pk_add_f32 v[132:133], v[132:133], v[140:141]
  v_pk_add_f32 v[134:135], v[134:135], v[142:143]
  v_cvt_pk_bf16_f32 v32, v128, v129
  v_cvt_pk_bf16_f32 v33, v130, v131
  v_lshlrev_b32 v128, 16, v32
  v_and_b32 v129, 0xffff0000, v32
  v_lshlrev_b32 v130, 16, v33
  v_and_b32 v131, 0xffff0000, v33
  v_lshlrev_b32 v34, 16, v144
  v_and_b32 v35, 0xffff0000, v144
  v_lshlrev_b32 v36, 16, v145
  v_and_b32 v37, 0xffff0000, v145
  v_lshlrev_b32 v38, 16, v148
  v_and_b32 v39, 0xffff0000, v148
  v_lshlrev_b32 v40, 16, v149
  v_and_b32 v41, 0xffff0000, v149
  v_lshlrev_b32 v42, 16, v154
  v_and_b32 v43, 0xffff0000, v154
  v_lshlrev_b32 v44, 16, v155
  v_and_b32 v45, 0xffff0000, v155
  v_pk_mul_f32 v[34:35], v[34:35], v[38:39]
  v_pk_mul_f32 v[36:37], v[36:37], v[40:41]
  v_cvt_pk_bf16_f32 v38, v34, v35
  v_cvt_pk_bf16_f32 v39, v36, v37
  v_lshlrev_b32 v34, 16, v38
  v_and_b32 v35, 0xffff0000, v38
  v_lshlrev_b32 v36, 16, v39
  v_and_b32 v37, 0xffff0000, v39
  v_pk_add_f32 v[34:35], v[34:35], v[42:43]
  v_pk_add_f32 v[36:37], v[36:37], v[44:45]
  v_cvt_pk_bf16_f32 v38, v34, v35
  v_cvt_pk_bf16_f32 v39, v36, v37
  v_lshlrev_b32 v34, 16, v38
  v_and_b32 v35, 0xffff0000, v38
  v_lshlrev_b32 v36, 16, v39
  v_and_b32 v37, 0xffff0000, v39
  v_pk_mul_f32 v[128:129], v[128:129], v[152:153] op_sel:[0,0] op_sel_hi:[1,0]
  v_pk_mul_f32 v[34:35], v[34:35], v[152:153] op_sel:[0,1] op_sel_hi:[1,1]
  v_pk_mul_f32 v[130:131], v[130:131], v[152:153] op_sel:[0,0] op_sel_hi:[1,0]
  v_pk_mul_f32 v[36:37], v[36:37], v[152:153] op_sel:[0,1] op_sel_hi:[1,1]
  v_cvt_pk_bf16_f32 v38, v128, v129
  v_cvt_pk_bf16_f32 v40, v34, v35
  v_cvt_pk_bf16_f32 v39, v130, v131
  v_cvt_pk_bf16_f32 v41, v36, v37
  v_lshlrev_b32 v128, 16, v38
  v_and_b32 v129, 0xffff0000, v38
  v_lshlrev_b32 v34, 16, v40
  v_and_b32 v35, 0xffff0000, v40
  v_lshlrev_b32 v130, 16, v39
  v_and_b32 v131, 0xffff0000, v39
  v_lshlrev_b32 v36, 16, v41
  v_and_b32 v37, 0xffff0000, v41
  v_pk_add_f32 v[128:129], v[128:129], v[34:35]
  v_pk_add_f32 v[130:131], v[130:131], v[36:37]
  v_cvt_pk_bf16_f32 v96, v128, v129
  v_cvt_pk_bf16_f32 v97, v130, v131
  v_cvt_pk_bf16_f32 v48, v132, v133
  v_cvt_pk_bf16_f32 v49, v134, v135
  v_lshlrev_b32 v132, 16, v48
  v_and_b32 v133, 0xffff0000, v48
  v_lshlrev_b32 v134, 16, v49
  v_and_b32 v135, 0xffff0000, v49
  v_lshlrev_b32 v50, 16, v146
  v_and_b32 v51, 0xffff0000, v146
  v_lshlrev_b32 v52, 16, v147
  v_and_b32 v53, 0xffff0000, v147
  v_lshlrev_b32 v54, 16, v150
  v_and_b32 v55, 0xffff0000, v150
  v_lshlrev_b32 v56, 16, v151
  v_and_b32 v57, 0xffff0000, v151
  v_lshlrev_b32 v58, 16, v156
  v_and_b32 v59, 0xffff0000, v156
  v_lshlrev_b32 v60, 16, v157
  v_and_b32 v61, 0xffff0000, v157
  v_pk_mul_f32 v[50:51], v[50:51], v[54:55]
  v_pk_mul_f32 v[52:53], v[52:53], v[56:57]
  v_cvt_pk_bf16_f32 v54, v50, v51
  v_cvt_pk_bf16_f32 v55, v52, v53
  v_lshlrev_b32 v50, 16, v54
  v_and_b32 v51, 0xffff0000, v54
  v_lshlrev_b32 v52, 16, v55
  v_and_b32 v53, 0xffff0000, v55
  v_pk_add_f32 v[50:51], v[50:51], v[58:59]
  v_pk_add_f32 v[52:53], v[52:53], v[60:61]
  v_cvt_pk_bf16_f32 v54, v50, v51
  v_cvt_pk_bf16_f32 v55, v52, v53
  v_lshlrev_b32 v50, 16, v54
  v_and_b32 v51, 0xffff0000, v54
  v_lshlrev_b32 v52, 16, v55
  v_and_b32 v53, 0xffff0000, v55
  v_pk_mul_f32 v[132:133], v[132:133], v[152:153] op_sel:[0,0] op_sel_hi:[1,0]
  v_pk_mul_f32 v[50:51], v[50:51], v[152:153] op_sel:[0,1] op_sel_hi:[1,1]
  v_pk_mul_f32 v[134:135], v[134:135], v[152:153] op_sel:[0,0] op_sel_hi:[1,0]
  v_pk_mul_f32 v[52:53], v[52:53], v[152:153] op_sel:[0,1] op_sel_hi:[1,1]
  v_cvt_pk_bf16_f32 v54, v132, v133
  v_cvt_pk_bf16_f32 v56, v50, v51
  v_cvt_pk_bf16_f32 v55, v134, v135
  v_cvt_pk_bf16_f32 v57, v52, v53
  v_lshlrev_b32 v132, 16, v54
  v_and_b32 v133, 0xffff0000, v54
  v_lshlrev_b32 v50, 16, v56
  v_and_b32 v51, 0xffff0000, v56
  v_lshlrev_b32 v134, 16, v55
  v_and_b32 v135, 0xffff0000, v55
  v_lshlrev_b32 v52, 16, v57
  v_and_b32 v53, 0xffff0000, v57
  v_pk_add_f32 v[132:133], v[132:133], v[50:51]
  v_pk_add_f32 v[134:135], v[134:135], v[52:53]
  v_cvt_pk_bf16_f32 v98, v132, v133
  v_cvt_pk_bf16_f32 v99, v134, v135
  s_nop 0
  v_permlane32_swap_b32 v96, v98
  v_permlane32_swap_b32 v97, v99
  v_lshl_add_u32 v13, v4, 4, v6
  s_nop 1
  buffer_store_dwordx4 v[96:99], v13, s[20:23], s49 offen
LFB_exit:
  s_endpgm
.section .rodata,"a"
.p2align 6
.amdhsa_kernel gated_mix__linear_kernel_hedgehog__ssm_conv_s4__prompt_kernel
  .amdhsa_next_free_vgpr 256
  .amdhsa_next_free_sgpr 100
  .amdhsa_accum_offset 256
  .amdhsa_group_segment_fixed_size 0
  .amdhsa_kernarg_size 136
  .amdhsa_user_sgpr_count 2
  .amdhsa_user_sgpr_kernarg_segment_ptr 1
  .amdhsa_system_sgpr_workgroup_id_x 1
.end_amdhsa_kernel
```
